```python
import torch

def _softmax(x, axis=-1):
    return torch.softmax(x, dim=axis)
def _gelu(x):
    return torch.nn.functional.gelu(x, approximate="tanh")
def _silu(x):
    return torch.nn.functional.silu(x)
def _sigmoid(x):
    return torch.sigmoid(x)
def _layernorm(x, axis=-1, eps=1e-5):
    m = x.mean(dim=axis, keepdim=True)
    v = x.var(dim=axis, keepdim=True, unbiased=False)
    return (x - m) / torch.sqrt(v + eps)
def _scatter_add(tgt, idx, src, axis=0):
    return tgt.clone().index_add_(axis, idx, src)
def _segment_sum(src, seg, n):
    out = torch.zeros((n,) + src.shape[1:], dtype=src.dtype)
    return out.index_add_(0, seg, src)
def _pad(x, pw):
    flat = tuple(v for pair in reversed(pw) for v in pair)
    return torch.nn.functional.pad(x, flat)

kernel_name = 'standalone__mha_softmax__near_ridge'

def setup_inputs():

    _w = (lambda a: (lambda t: t.to(torch.bfloat16) if t.is_floating_point() else t)(torch.as_tensor(a)))
    B, H, Sq, Sk, D = 8, 32, 384, 2048, 128
    return {
        "q": _w((lambda *s: torch.randn(*s, dtype=torch.bfloat16) * 0.8)(B, H, Sq, D)),
        "k": _w((lambda *s: torch.randn(*s, dtype=torch.bfloat16) * 0.8)(B, H, Sk, D)),
        "v": _w((lambda *s: torch.randn(*s, dtype=torch.bfloat16) * 0.05)(B, H, Sk, D)),
    }

def reference(q, k, v):
    scale = q.shape[-1] ** -0.5
    scores = torch.einsum("bhqd,bhkd->bhqk", q, k) * scale
    p = _softmax(scores, axis=-1)
    return torch.einsum("bhqk,bhkd->bhqd", p, v)
```

```asm
; @launch grid=(256,1,1) block=(256,1,1) lds=136192
.amdgcn_target "amdgcn-amd-amdhsa--gfx950"
.text
.globl standalone__mha_softmax__near_ridge_kernel
.p2align 8
.type standalone__mha_softmax__near_ridge_kernel,@function
standalone__mha_softmax__near_ridge_kernel:
    s_load_dwordx4 s[32:35], s[0:1], 0
    s_load_dwordx4 s[36:39], s[0:1], 16
    s_cmpk_ge_u32 s2, 0x100
    s_cbranch_scc1 L_end
    v_lshrrev_b32 v229, 6, v0
    v_bfe_u32 v230, v0, 2, 2
    v_bfe_u32 v228, v0, 4, 2
    v_readfirstlane_b32 s20, v229
    v_and_b32 v231, 3, v0
    v_lshlrev_b32 v239, 8, v230
    v_lshl_add_u32 v239, v228, 6, v239
    v_lshl_add_u32 v239, v231, 4, v239
    s_lshl_b32 s24, s20, 11
    s_mul_i32 s21, s20, 4224
    v_add_u32 v225, s24, v239
    v_add_u32 v224, 32, v225
    s_mul_i32 s24, s20, 24576
    v_add_u32 v239, s24, v239
    v_add_u32 v238, 32, v239
    v_add_u32 v237, 32, v238
    v_add_u32 v236, 32, v237
    s_mul_i32 s88, s20, 8704
    s_add_u32 s88, s88, 101376
    s_mul_i32 s24, s2, 98304
    s_lshl_b32 s25, s2, 19
    s_mov_b32 s11, 0x20000
    s_mov_b32 s10, 524320
    s_mov_b32 s7, s11
    s_mov_b32 s6, s10
    s_mov_b32 s15, s11
    s_mov_b32 s14, s10
    s_mov_b32 s22, 0
    s_mov_b32 m0, s21
    s_waitcnt lgkmcnt(0)
    s_add_u32 s8, s34, s25
    s_addc_u32 s9, s35, 0
    s_sub_u32 s8, s8, 32
    s_subb_u32 s9, s9, 0
    buffer_load_dwordx4 v224, s[8:11], s22 offen nt lds
    buffer_load_dwordx4 v225, s[8:11], s22 offen offset:1056 nt lds
    s_add_u32 s4, s32, s24
    s_addc_u32 s5, s33, 0
    s_sub_u32 s4, s4, 96
    s_subb_u32 s5, s5, 0
    s_mov_b32 m0, s88
    s_add_u32 s12, s36, s25
    buffer_load_dwordx4 v236, s[4:7], s22 offen nt lds
    buffer_load_dwordx4 v237, s[4:7], s22 offen offset:1056 nt lds
    buffer_load_dwordx4 v238, s[4:7], s22 offen offset:2112 nt lds
    buffer_load_dwordx4 v239, s[4:7], s22 offen offset:3168 nt lds
    s_addc_u32 s13, s37, 0
    s_sub_u32 s12, s12, 2144
    s_mov_b32 m0, s21
    s_subb_u32 s13, s13, 0
    buffer_load_dwordx4 v224, s[12:15], s22 offen offset:2112 nt lds
    buffer_load_dwordx4 v225, s[12:15], s22 offen offset:3168 nt lds
    s_add_u32 m0, s21, 16896
    s_movk_i32 s22, 0x2000
    buffer_load_dwordx4 v224, s[8:11], s22 offen nt lds
    buffer_load_dwordx4 v225, s[8:11], s22 offen offset:1056 nt lds
    buffer_load_dwordx4 v224, s[12:15], s22 offen offset:2112 nt lds
    buffer_load_dwordx4 v225, s[12:15], s22 offen offset:3168 nt lds
    s_mov_b32 s6, 98400
    s_mov_b32 s14, 526432
    s_mov_b32 s18, 98304
    s_mov_b32 s19, s11
    s_add_u32 s16, s38, s24
    s_addc_u32 s17, s39, 0
    v_and_b32 v226, 63, v0
    v_lshrrev_b32 v222, 1, v230
    v_mul_u32_u24 v222, 4224, v222
    v_and_b32 v223, 1, v230
    v_mul_u32_u24 v223, 1056, v223
    v_add_u32 v222, v222, v223
    v_lshl_add_u32 v222, v231, 6, v222
    v_lshl_add_u32 v222, v228, 4, v222
    v_mul_u32_u24 v240, 1056, v230
    v_lshl_add_u32 v240, v231, 6, v240
    v_lshl_add_u32 v240, v228, 4, v240
    v_add_u32 v241, s21, v240
    v_add_u32 v241, 67584, v241
    v_add_u32 v240, s88, v240
    v_lshrrev_b32 v223, 1, v228
    v_mul_u32_u24 v223, 4224, v223
    v_and_b32 v229, 1, v228
    v_mul_u32_u24 v242, 1056, v229
    v_add_u32 v223, v223, v242
    v_lshl_add_u32 v223, v230, 6, v223
    v_lshl_add_u32 v223, v231, 3, v223
    v_add_u32 v223, 2112, v223
    v_mov_b32 v216, 0
    v_mov_b32 v217, 0
    v_mov_b32 v218, 0
    v_mov_b32 v219, 0
    v_mov_b32 v220, 0
    v_mov_b32 v221, 0
    v_and_b32 v242, 15, v226
    v_lshrrev_b32 v243, 4, v226
    v_mul_u32_u24 v230, 272, v242
    v_lshl_add_u32 v230, v243, 3, v230
    v_add_u32 v230, s88, v230
    v_mul_u32_u24 v231, 272, v243
    v_lshl_add_u32 v231, v242, 4, v231
    v_add_u32 v231, s88, v231
    s_mul_i32 s25, s20, 24576
    v_lshlrev_b32 v227, 4, v226
    v_add_u32 v227, s25, v227
    s_mov_b32 s25, 0x3e0293ee
    v_mov_b32 v228, s25
    v_mov_b32 v229, s25
    s_mov_b32 s26, 0xffff0000
    s_add_u32 m0, s88, 4352
    s_movk_i32 s27, 4096
    buffer_load_dwordx4 v236, s[4:7], s27 offen nt lds
    buffer_load_dwordx4 v237, s[4:7], s27 offen offset:1056 nt lds
    buffer_load_dwordx4 v238, s[4:7], s27 offen offset:2112 nt lds
    buffer_load_dwordx4 v239, s[4:7], s27 offen offset:3168 nt lds
    s_waitcnt vmcnt(10)
    ds_read_b128 v[160:163], v240 offset:0
    ds_read_b128 v[164:167], v240 offset:256
    ds_read_b128 v[168:171], v240 offset:512
    ds_read_b128 v[172:175], v240 offset:768
    s_waitcnt lgkmcnt(0)
    s_add_u32 m0, s21, 84480
    s_movk_i32 s27, 8192
    buffer_load_dwordx4 v236, s[4:7], s27 offen nt lds
    buffer_load_dwordx4 v237, s[4:7], s27 offen offset:1056 nt lds
    buffer_load_dwordx4 v238, s[4:7], s27 offen offset:2112 nt lds
    buffer_load_dwordx4 v239, s[4:7], s27 offen offset:3168 nt lds
    v_lshlrev_b32 v232, 16, v160
    v_and_b32 v233, s26, v160
    v_pk_mul_f32 v[232:233], v[232:233], v[228:229]
    v_cvt_pk_bf16_f32 v232, v232, v233
    v_accvgpr_write_b32 a0, v232
    v_lshlrev_b32 v234, 16, v161
    v_and_b32 v235, s26, v161
    v_pk_mul_f32 v[234:235], v[234:235], v[228:229]
    v_cvt_pk_bf16_f32 v234, v234, v235
    v_accvgpr_write_b32 a1, v234
    v_lshlrev_b32 v232, 16, v162
    v_and_b32 v233, s26, v162
    v_pk_mul_f32 v[232:233], v[232:233], v[228:229]
    v_cvt_pk_bf16_f32 v232, v232, v233
    v_accvgpr_write_b32 a2, v232
    v_lshlrev_b32 v234, 16, v163
    v_and_b32 v235, s26, v163
    v_pk_mul_f32 v[234:235], v[234:235], v[228:229]
    v_cvt_pk_bf16_f32 v234, v234, v235
    v_accvgpr_write_b32 a3, v234
    v_lshlrev_b32 v232, 16, v164
    v_and_b32 v233, s26, v164
    v_pk_mul_f32 v[232:233], v[232:233], v[228:229]
    v_cvt_pk_bf16_f32 v232, v232, v233
    v_accvgpr_write_b32 a4, v232
    v_lshlrev_b32 v234, 16, v165
    v_and_b32 v235, s26, v165
    v_pk_mul_f32 v[234:235], v[234:235], v[228:229]
    v_cvt_pk_bf16_f32 v234, v234, v235
    v_accvgpr_write_b32 a5, v234
    v_lshlrev_b32 v232, 16, v166
    v_and_b32 v233, s26, v166
    v_pk_mul_f32 v[232:233], v[232:233], v[228:229]
    v_cvt_pk_bf16_f32 v232, v232, v233
    v_accvgpr_write_b32 a6, v232
    v_lshlrev_b32 v234, 16, v167
    v_and_b32 v235, s26, v167
    v_pk_mul_f32 v[234:235], v[234:235], v[228:229]
    v_cvt_pk_bf16_f32 v234, v234, v235
    v_accvgpr_write_b32 a7, v234
    v_lshlrev_b32 v232, 16, v168
    v_and_b32 v233, s26, v168
    v_pk_mul_f32 v[232:233], v[232:233], v[228:229]
    v_cvt_pk_bf16_f32 v232, v232, v233
    v_accvgpr_write_b32 a8, v232
    v_lshlrev_b32 v234, 16, v169
    v_and_b32 v235, s26, v169
    v_pk_mul_f32 v[234:235], v[234:235], v[228:229]
    v_cvt_pk_bf16_f32 v234, v234, v235
    v_accvgpr_write_b32 a9, v234
    v_lshlrev_b32 v232, 16, v170
    v_and_b32 v233, s26, v170
    v_pk_mul_f32 v[232:233], v[232:233], v[228:229]
    v_cvt_pk_bf16_f32 v232, v232, v233
    v_accvgpr_write_b32 a10, v232
    v_lshlrev_b32 v234, 16, v171
    v_and_b32 v235, s26, v171
    v_pk_mul_f32 v[234:235], v[234:235], v[228:229]
    v_cvt_pk_bf16_f32 v234, v234, v235
    v_accvgpr_write_b32 a11, v234
    v_lshlrev_b32 v232, 16, v172
    v_and_b32 v233, s26, v172
    v_pk_mul_f32 v[232:233], v[232:233], v[228:229]
    v_cvt_pk_bf16_f32 v232, v232, v233
    v_accvgpr_write_b32 a12, v232
    v_lshlrev_b32 v234, 16, v173
    v_and_b32 v235, s26, v173
    v_pk_mul_f32 v[234:235], v[234:235], v[228:229]
    v_cvt_pk_bf16_f32 v234, v234, v235
    v_accvgpr_write_b32 a13, v234
    v_lshlrev_b32 v232, 16, v174
    v_and_b32 v233, s26, v174
    v_pk_mul_f32 v[232:233], v[232:233], v[228:229]
    v_cvt_pk_bf16_f32 v232, v232, v233
    v_accvgpr_write_b32 a14, v232
    v_lshlrev_b32 v234, 16, v175
    v_and_b32 v235, s26, v175
    v_pk_mul_f32 v[234:235], v[234:235], v[228:229]
    v_cvt_pk_bf16_f32 v234, v234, v235
    v_accvgpr_write_b32 a15, v234
    s_waitcnt vmcnt(8)
    s_barrier
    ds_read_b128 a[96:99], v222 offset:0
    ds_read_b128 a[100:103], v222 offset:256
    ds_read_b128 a[104:107], v222 offset:512
    ds_read_b128 a[108:111], v222 offset:768
    ds_read_b128 a[112:115], v222 offset:8448
    ds_read_b128 a[116:119], v222 offset:8704
    ds_read_b128 a[120:123], v222 offset:8960
    ds_read_b128 a[124:127], v222 offset:9216
    ds_read_b128 a[128:131], v222 offset:16896
    ds_read_b128 a[132:135], v222 offset:17152
    ds_read_b128 a[136:139], v222 offset:17408
    ds_read_b128 a[140:143], v222 offset:17664
    ds_read_b128 a[144:147], v222 offset:25344
    ds_read_b128 a[148:151], v222 offset:25600
    ds_read_b128 a[152:155], v222 offset:25856
    ds_read_b128 a[156:159], v222 offset:26112
    s_waitcnt lgkmcnt(8)
    v_mfma_f32_16x16x32_bf16 v[192:195], a[96:99], a[0:3], 0
    ds_read_b64_tr_b16 a[160:161], v223 offset:0
    ds_read_b64_tr_b16 a[162:163], v223 offset:8448
    v_mfma_f32_16x16x32_bf16 v[192:195], a[100:103], a[4:7], v[192:195]
    ds_read_b64_tr_b16 a[164:165], v223 offset:32
    ds_read_b64_tr_b16 a[166:167], v223 offset:8480
    v_mfma_f32_16x16x32_bf16 v[192:195], a[104:107], a[8:11], v[192:195]
    ds_read_b64_tr_b16 a[168:169], v223 offset:256
    ds_read_b64_tr_b16 a[170:171], v223 offset:8704
    v_mfma_f32_16x16x32_bf16 v[192:195], a[108:111], a[12:15], v[192:195]
    ds_read_b64_tr_b16 a[172:173], v223 offset:288
    ds_read_b64_tr_b16 a[174:175], v223 offset:8736
    v_mfma_f32_16x16x32_bf16 v[196:199], a[124:127], a[12:15], 0
    ds_read_b64_tr_b16 a[176:177], v223 offset:512
    ds_read_b64_tr_b16 a[178:179], v223 offset:8960
    v_mfma_f32_16x16x32_bf16 v[196:199], a[120:123], a[8:11], v[196:199]
    ds_read_b64_tr_b16 a[180:181], v223 offset:544
    ds_read_b64_tr_b16 a[182:183], v223 offset:8992
    v_mfma_f32_16x16x32_bf16 v[196:199], a[116:119], a[4:7], v[196:199]
    ds_read_b64_tr_b16 a[184:185], v223 offset:768
    ds_read_b64_tr_b16 a[186:187], v223 offset:9216
    v_mfma_f32_16x16x32_bf16 v[196:199], a[112:115], a[0:3], v[196:199]
    ds_read_b64_tr_b16 a[188:189], v223 offset:800
    ds_read_b64_tr_b16 a[190:191], v223 offset:9248
    s_waitcnt lgkmcnt(15)
    s_add_u32 m0, s21, 67584
    s_movk_i32 s27, 12288
    buffer_load_dwordx4 v236, s[4:7], s27 offen nt lds
    buffer_load_dwordx4 v237, s[4:7], s27 offen offset:1056 nt lds
    buffer_load_dwordx4 v238, s[4:7], s27 offen offset:2112 nt lds
    buffer_load_dwordx4 v239, s[4:7], s27 offen offset:3168 nt lds
    v_mfma_f32_16x16x32_bf16 v[200:203], a[128:131], a[0:3], 0
    v_exp_f32 v192, v192
    ds_read_b64_tr_b16 a[192:193], v223 offset:16896
    v_mfma_f32_16x16x32_bf16 v[200:203], a[132:135], a[4:7], v[200:203]
    v_exp_f32 v193, v193
    ds_read_b64_tr_b16 a[194:195], v223 offset:25344
    v_mfma_f32_16x16x32_bf16 v[200:203], a[136:139], a[8:11], v[200:203]
    v_add_f32 v216, v216, v192
    ds_read_b64_tr_b16 a[196:197], v223 offset:16928
    v_mfma_f32_16x16x32_bf16 v[200:203], a[140:143], a[12:15], v[200:203]
    v_exp_f32 v194, v194
    ds_read_b64_tr_b16 a[198:199], v223 offset:25376
    v_mfma_f32_16x16x32_bf16 v[204:207], a[156:159], a[12:15], 0
    v_add_f32 v216, v216, v193
    v_cvt_pk_bf16_f32 v208, v192, v193
    ds_read_b64_tr_b16 a[200:201], v223 offset:17152
    v_mfma_f32_16x16x32_bf16 v[204:207], a[152:155], a[8:11], v[204:207]
    v_exp_f32 v195, v195
    ds_read_b64_tr_b16 a[202:203], v223 offset:25600
    v_mfma_f32_16x16x32_bf16 v[204:207], a[148:151], a[4:7], v[204:207]
    v_add_f32 v216, v216, v194
    ds_read_b64_tr_b16 a[204:205], v223 offset:17184
    v_mfma_f32_16x16x32_bf16 v[204:207], a[144:147], a[0:3], v[204:207]
    v_exp_f32 v196, v196
    ds_read_b64_tr_b16 a[206:207], v223 offset:25632
    v_add_f32 v216, v216, v195
    v_cvt_pk_bf16_f32 v209, v194, v195
    ds_read_b64_tr_b16 a[208:209], v223 offset:17408
    v_exp_f32 v197, v197
    ds_read_b64_tr_b16 a[210:211], v223 offset:25856
    v_add_f32 v216, v216, v196
    ds_read_b64_tr_b16 a[212:213], v223 offset:17440
    v_exp_f32 v198, v198
    ds_read_b64_tr_b16 a[214:215], v223 offset:25888
    v_add_f32 v216, v216, v197
    v_cvt_pk_bf16_f32 v210, v196, v197
    ds_read_b64_tr_b16 a[216:217], v223 offset:17664
    v_exp_f32 v199, v199
    ds_read_b64_tr_b16 a[218:219], v223 offset:26112
    v_add_f32 v216, v216, v198
    ds_read_b64_tr_b16 a[220:221], v223 offset:17696
    v_add_f32 v216, v216, v199
    v_cvt_pk_bf16_f32 v211, v198, v199
    ds_read_b64_tr_b16 a[222:223], v223 offset:26144
    s_waitcnt vmcnt(8)
    ds_read_b128 v[160:163], v240 offset:4352
    ds_read_b128 v[164:167], v240 offset:4608
    ds_read_b128 v[168:171], v240 offset:4864
    ds_read_b128 v[172:175], v240 offset:5120
    s_waitcnt lgkmcnt(0)
    v_lshlrev_b32 v232, 16, v160
    v_and_b32 v233, s26, v160
    v_pk_mul_f32 v[232:233], v[232:233], v[228:229]
    v_cvt_pk_bf16_f32 v232, v232, v233
    v_accvgpr_write_b32 a16, v232
    v_lshlrev_b32 v234, 16, v161
    v_and_b32 v235, s26, v161
    v_pk_mul_f32 v[234:235], v[234:235], v[228:229]
    v_cvt_pk_bf16_f32 v234, v234, v235
    v_accvgpr_write_b32 a17, v234
    v_lshlrev_b32 v232, 16, v162
    v_and_b32 v233, s26, v162
    v_pk_mul_f32 v[232:233], v[232:233], v[228:229]
    v_cvt_pk_bf16_f32 v232, v232, v233
    v_accvgpr_write_b32 a18, v232
    v_lshlrev_b32 v234, 16, v163
    v_and_b32 v235, s26, v163
    v_pk_mul_f32 v[234:235], v[234:235], v[228:229]
    v_cvt_pk_bf16_f32 v234, v234, v235
    v_accvgpr_write_b32 a19, v234
    v_lshlrev_b32 v232, 16, v164
    v_and_b32 v233, s26, v164
    v_pk_mul_f32 v[232:233], v[232:233], v[228:229]
    v_cvt_pk_bf16_f32 v232, v232, v233
    v_accvgpr_write_b32 a20, v232
    v_lshlrev_b32 v234, 16, v165
    v_and_b32 v235, s26, v165
    v_pk_mul_f32 v[234:235], v[234:235], v[228:229]
    v_cvt_pk_bf16_f32 v234, v234, v235
    v_accvgpr_write_b32 a21, v234
    v_lshlrev_b32 v232, 16, v166
    v_and_b32 v233, s26, v166
    v_pk_mul_f32 v[232:233], v[232:233], v[228:229]
    v_cvt_pk_bf16_f32 v232, v232, v233
    v_accvgpr_write_b32 a22, v232
    v_lshlrev_b32 v234, 16, v167
    v_and_b32 v235, s26, v167
    v_pk_mul_f32 v[234:235], v[234:235], v[228:229]
    v_cvt_pk_bf16_f32 v234, v234, v235
    v_accvgpr_write_b32 a23, v234
    v_lshlrev_b32 v232, 16, v168
    v_and_b32 v233, s26, v168
    v_pk_mul_f32 v[232:233], v[232:233], v[228:229]
    v_cvt_pk_bf16_f32 v232, v232, v233
    v_accvgpr_write_b32 a24, v232
    v_lshlrev_b32 v234, 16, v169
    v_and_b32 v235, s26, v169
    v_pk_mul_f32 v[234:235], v[234:235], v[228:229]
    v_cvt_pk_bf16_f32 v234, v234, v235
    v_accvgpr_write_b32 a25, v234
    v_lshlrev_b32 v232, 16, v170
    v_and_b32 v233, s26, v170
    v_pk_mul_f32 v[232:233], v[232:233], v[228:229]
    v_cvt_pk_bf16_f32 v232, v232, v233
    v_accvgpr_write_b32 a26, v232
    v_lshlrev_b32 v234, 16, v171
    v_and_b32 v235, s26, v171
    v_pk_mul_f32 v[234:235], v[234:235], v[228:229]
    v_cvt_pk_bf16_f32 v234, v234, v235
    v_accvgpr_write_b32 a27, v234
    v_lshlrev_b32 v232, 16, v172
    v_and_b32 v233, s26, v172
    v_pk_mul_f32 v[232:233], v[232:233], v[228:229]
    v_cvt_pk_bf16_f32 v232, v232, v233
    v_accvgpr_write_b32 a28, v232
    v_lshlrev_b32 v234, 16, v173
    v_and_b32 v235, s26, v173
    v_pk_mul_f32 v[234:235], v[234:235], v[228:229]
    v_cvt_pk_bf16_f32 v234, v234, v235
    v_accvgpr_write_b32 a29, v234
    v_lshlrev_b32 v232, 16, v174
    v_and_b32 v233, s26, v174
    v_pk_mul_f32 v[232:233], v[232:233], v[228:229]
    v_cvt_pk_bf16_f32 v232, v232, v233
    v_accvgpr_write_b32 a30, v232
    v_lshlrev_b32 v234, 16, v175
    v_and_b32 v235, s26, v175
    v_pk_mul_f32 v[234:235], v[234:235], v[228:229]
    v_cvt_pk_bf16_f32 v234, v234, v235
    v_accvgpr_write_b32 a31, v234
    s_nop 1
    v_mfma_f32_16x16x32_bf16 v[192:195], a[96:99], a[16:19], 0
    v_exp_f32 v200, v200
    v_mfma_f32_16x16x32_bf16 v[192:195], a[100:103], a[20:23], v[192:195]
    v_exp_f32 v201, v201
    v_mfma_f32_16x16x32_bf16 v[192:195], a[104:107], a[24:27], v[192:195]
    v_add_f32 v216, v216, v200
    s_mov_b32 m0, s88
    v_mfma_f32_16x16x32_bf16 v[192:195], a[108:111], a[28:31], v[192:195]
    v_exp_f32 v202, v202
    v_mfma_f32_16x16x32_bf16 v[196:199], a[124:127], a[28:31], 0
    v_add_f32 v216, v216, v201
    v_cvt_pk_bf16_f32 v244, v200, v201
    v_mfma_f32_16x16x32_bf16 v[196:199], a[120:123], a[24:27], v[196:199]
    v_exp_f32 v203, v203
    s_movk_i32 s27, 16384
    v_mfma_f32_16x16x32_bf16 v[196:199], a[116:119], a[20:23], v[196:199]
    v_add_f32 v216, v216, v202
    v_mfma_f32_16x16x32_bf16 v[196:199], a[112:115], a[16:19], v[196:199]
    v_exp_f32 v204, v204
    buffer_load_dwordx4 v236, s[4:7], s27 offen nt lds
    v_mfma_f32_16x16x32_bf16 v[0:3], a[160:163], v[208:211], 0
    v_add_f32 v216, v216, v203
    v_cvt_pk_bf16_f32 v245, v202, v203
    v_mfma_f32_16x16x32_bf16 v[4:7], a[164:167], v[208:211], 0
    v_exp_f32 v205, v205
    v_mfma_f32_16x16x32_bf16 v[8:11], a[168:171], v[208:211], 0
    v_add_f32 v216, v216, v204
    buffer_load_dwordx4 v237, s[4:7], s27 offen offset:1056 nt lds
    v_mfma_f32_16x16x32_bf16 v[12:15], a[172:175], v[208:211], 0
    v_exp_f32 v206, v206
    v_mfma_f32_16x16x32_bf16 v[16:19], a[176:179], v[208:211], 0
    v_add_f32 v216, v216, v205
    v_cvt_pk_bf16_f32 v246, v204, v205
    v_mfma_f32_16x16x32_bf16 v[20:23], a[180:183], v[208:211], 0
    v_exp_f32 v207, v207
    buffer_load_dwordx4 v238, s[4:7], s27 offen offset:2112 nt lds
    v_mfma_f32_16x16x32_bf16 v[24:27], a[184:187], v[208:211], 0
    v_add_f32 v216, v216, v206
    v_mfma_f32_16x16x32_bf16 v[28:31], a[188:191], v[208:211], 0
    v_add_f32 v216, v216, v207
    v_cvt_pk_bf16_f32 v247, v206, v207
    buffer_load_dwordx4 v239, s[4:7], s27 offen offset:3168 nt lds
    s_waitcnt vmcnt(8)
    ds_read_b128 v[160:163], v241 offset:16896
    ds_read_b128 v[164:167], v241 offset:17152
    ds_read_b128 v[168:171], v241 offset:17408
    ds_read_b128 v[172:175], v241 offset:17664
    v_mfma_f32_16x16x32_bf16 v[200:203], a[128:131], a[16:19], 0
    v_exp_f32 v192, v192
    v_mfma_f32_16x16x32_bf16 v[200:203], a[132:135], a[20:23], v[200:203]
    v_exp_f32 v193, v193
    v_mfma_f32_16x16x32_bf16 v[200:203], a[136:139], a[24:27], v[200:203]
    v_add_f32 v217, v217, v192
    v_mfma_f32_16x16x32_bf16 v[200:203], a[140:143], a[28:31], v[200:203]
    v_exp_f32 v194, v194
    v_mfma_f32_16x16x32_bf16 v[204:207], a[156:159], a[28:31], 0
    v_add_f32 v217, v217, v193
    v_cvt_pk_bf16_f32 v208, v192, v193
    v_mfma_f32_16x16x32_bf16 v[204:207], a[152:155], a[24:27], v[204:207]
    v_exp_f32 v195, v195
    v_mfma_f32_16x16x32_bf16 v[204:207], a[148:151], a[20:23], v[204:207]
    v_add_f32 v217, v217, v194
    v_mfma_f32_16x16x32_bf16 v[204:207], a[144:147], a[16:19], v[204:207]
    v_exp_f32 v196, v196
    v_add_f32 v217, v217, v195
    v_cvt_pk_bf16_f32 v209, v194, v195
    v_exp_f32 v197, v197
    v_add_f32 v217, v217, v196
    v_exp_f32 v198, v198
    v_add_f32 v217, v217, v197
    v_cvt_pk_bf16_f32 v210, v196, v197
    v_exp_f32 v199, v199
    v_add_f32 v217, v217, v198
    v_add_f32 v217, v217, v199
    v_cvt_pk_bf16_f32 v211, v198, v199
    s_waitcnt lgkmcnt(0)
    v_lshlrev_b32 v232, 16, v160
    v_and_b32 v233, s26, v160
    v_pk_mul_f32 v[232:233], v[232:233], v[228:229]
    v_cvt_pk_bf16_f32 v232, v232, v233
    v_accvgpr_write_b32 a32, v232
    v_lshlrev_b32 v234, 16, v161
    v_and_b32 v235, s26, v161
    v_pk_mul_f32 v[234:235], v[234:235], v[228:229]
    v_cvt_pk_bf16_f32 v234, v234, v235
    v_accvgpr_write_b32 a33, v234
    v_lshlrev_b32 v232, 16, v162
    v_and_b32 v233, s26, v162
    v_pk_mul_f32 v[232:233], v[232:233], v[228:229]
    v_cvt_pk_bf16_f32 v232, v232, v233
    v_accvgpr_write_b32 a34, v232
    v_lshlrev_b32 v234, 16, v163
    v_and_b32 v235, s26, v163
    v_pk_mul_f32 v[234:235], v[234:235], v[228:229]
    v_cvt_pk_bf16_f32 v234, v234, v235
    v_accvgpr_write_b32 a35, v234
    v_lshlrev_b32 v232, 16, v164
    v_and_b32 v233, s26, v164
    v_pk_mul_f32 v[232:233], v[232:233], v[228:229]
    v_cvt_pk_bf16_f32 v232, v232, v233
    v_accvgpr_write_b32 a36, v232
    v_lshlrev_b32 v234, 16, v165
    v_and_b32 v235, s26, v165
    v_pk_mul_f32 v[234:235], v[234:235], v[228:229]
    v_cvt_pk_bf16_f32 v234, v234, v235
    v_accvgpr_write_b32 a37, v234
    v_lshlrev_b32 v232, 16, v166
    v_and_b32 v233, s26, v166
    v_pk_mul_f32 v[232:233], v[232:233], v[228:229]
    v_cvt_pk_bf16_f32 v232, v232, v233
    v_accvgpr_write_b32 a38, v232
    v_lshlrev_b32 v234, 16, v167
    v_and_b32 v235, s26, v167
    v_pk_mul_f32 v[234:235], v[234:235], v[228:229]
    v_cvt_pk_bf16_f32 v234, v234, v235
    v_accvgpr_write_b32 a39, v234
    v_lshlrev_b32 v232, 16, v168
    v_and_b32 v233, s26, v168
    v_pk_mul_f32 v[232:233], v[232:233], v[228:229]
    v_cvt_pk_bf16_f32 v232, v232, v233
    v_accvgpr_write_b32 a40, v232
    v_lshlrev_b32 v234, 16, v169
    v_and_b32 v235, s26, v169
    v_pk_mul_f32 v[234:235], v[234:235], v[228:229]
    v_cvt_pk_bf16_f32 v234, v234, v235
    v_accvgpr_write_b32 a41, v234
    v_lshlrev_b32 v232, 16, v170
    v_and_b32 v233, s26, v170
    v_pk_mul_f32 v[232:233], v[232:233], v[228:229]
    v_cvt_pk_bf16_f32 v232, v232, v233
    v_accvgpr_write_b32 a42, v232
    v_lshlrev_b32 v234, 16, v171
    v_and_b32 v235, s26, v171
    v_pk_mul_f32 v[234:235], v[234:235], v[228:229]
    v_cvt_pk_bf16_f32 v234, v234, v235
    v_accvgpr_write_b32 a43, v234
    v_lshlrev_b32 v232, 16, v172
    v_and_b32 v233, s26, v172
    v_pk_mul_f32 v[232:233], v[232:233], v[228:229]
    v_cvt_pk_bf16_f32 v232, v232, v233
    v_accvgpr_write_b32 a44, v232
    v_lshlrev_b32 v234, 16, v173
    v_and_b32 v235, s26, v173
    v_pk_mul_f32 v[234:235], v[234:235], v[228:229]
    v_cvt_pk_bf16_f32 v234, v234, v235
    v_accvgpr_write_b32 a45, v234
    v_lshlrev_b32 v232, 16, v174
    v_and_b32 v233, s26, v174
    v_pk_mul_f32 v[232:233], v[232:233], v[228:229]
    v_cvt_pk_bf16_f32 v232, v232, v233
    v_accvgpr_write_b32 a46, v232
    v_lshlrev_b32 v234, 16, v175
    v_and_b32 v235, s26, v175
    v_pk_mul_f32 v[234:235], v[234:235], v[228:229]
    v_cvt_pk_bf16_f32 v234, v234, v235
    v_accvgpr_write_b32 a47, v234
    s_nop 1
    v_mfma_f32_16x16x32_bf16 v[192:195], a[96:99], a[32:35], 0
    v_exp_f32 v200, v200
    v_mfma_f32_16x16x32_bf16 v[192:195], a[100:103], a[36:39], v[192:195]
    v_exp_f32 v201, v201
    v_mfma_f32_16x16x32_bf16 v[192:195], a[104:107], a[40:43], v[192:195]
    v_add_f32 v217, v217, v200
    s_add_u32 m0, s88, 4352
    v_mfma_f32_16x16x32_bf16 v[192:195], a[108:111], a[44:47], v[192:195]
    v_exp_f32 v202, v202
    v_mfma_f32_16x16x32_bf16 v[196:199], a[124:127], a[44:47], 0
    v_add_f32 v217, v217, v201
    v_cvt_pk_bf16_f32 v212, v200, v201
    v_mfma_f32_16x16x32_bf16 v[196:199], a[120:123], a[40:43], v[196:199]
    v_exp_f32 v203, v203
    s_movk_i32 s27, 20480
    v_mfma_f32_16x16x32_bf16 v[196:199], a[116:119], a[36:39], v[196:199]
    v_add_f32 v217, v217, v202
    v_mfma_f32_16x16x32_bf16 v[196:199], a[112:115], a[32:35], v[196:199]
    v_exp_f32 v204, v204
    buffer_load_dwordx4 v236, s[4:7], s27 offen nt lds
    v_mfma_f32_16x16x32_bf16 v[32:35], a[160:163], v[208:211], 0
    v_add_f32 v217, v217, v203
    v_cvt_pk_bf16_f32 v213, v202, v203
    v_mfma_f32_16x16x32_bf16 v[36:39], a[164:167], v[208:211], 0
    v_exp_f32 v205, v205
    v_mfma_f32_16x16x32_bf16 v[40:43], a[168:171], v[208:211], 0
    v_add_f32 v217, v217, v204
    buffer_load_dwordx4 v237, s[4:7], s27 offen offset:1056 nt lds
    v_mfma_f32_16x16x32_bf16 v[44:47], a[172:175], v[208:211], 0
    v_exp_f32 v206, v206
    v_mfma_f32_16x16x32_bf16 v[48:51], a[176:179], v[208:211], 0
    v_add_f32 v217, v217, v205
    v_cvt_pk_bf16_f32 v214, v204, v205
    v_mfma_f32_16x16x32_bf16 v[52:55], a[180:183], v[208:211], 0
    v_exp_f32 v207, v207
    buffer_load_dwordx4 v238, s[4:7], s27 offen offset:2112 nt lds
    v_mfma_f32_16x16x32_bf16 v[56:59], a[184:187], v[208:211], 0
    v_add_f32 v217, v217, v206
    v_mfma_f32_16x16x32_bf16 v[60:63], a[188:191], v[208:211], 0
    v_add_f32 v217, v217, v207
    v_cvt_pk_bf16_f32 v215, v206, v207
    buffer_load_dwordx4 v239, s[4:7], s27 offen offset:3168 nt lds
    s_waitcnt vmcnt(8)
    ds_read_b128 v[160:163], v241 offset:0
    ds_read_b128 v[164:167], v241 offset:256
    ds_read_b128 v[168:171], v241 offset:512
    ds_read_b128 v[172:175], v241 offset:768
    v_mfma_f32_16x16x32_bf16 v[200:203], a[128:131], a[32:35], 0
    v_exp_f32 v192, v192
    v_mfma_f32_16x16x32_bf16 v[200:203], a[132:135], a[36:39], v[200:203]
    v_exp_f32 v193, v193
    v_mfma_f32_16x16x32_bf16 v[200:203], a[136:139], a[40:43], v[200:203]
    v_add_f32 v218, v218, v192
    v_mfma_f32_16x16x32_bf16 v[200:203], a[140:143], a[44:47], v[200:203]
    v_exp_f32 v194, v194
    v_mfma_f32_16x16x32_bf16 v[204:207], a[156:159], a[44:47], 0
    v_add_f32 v218, v218, v193
    v_cvt_pk_bf16_f32 v208, v192, v193
    v_mfma_f32_16x16x32_bf16 v[204:207], a[152:155], a[40:43], v[204:207]
    v_exp_f32 v195, v195
    v_mfma_f32_16x16x32_bf16 v[204:207], a[148:151], a[36:39], v[204:207]
    v_add_f32 v218, v218, v194
    v_mfma_f32_16x16x32_bf16 v[204:207], a[144:147], a[32:35], v[204:207]
    v_exp_f32 v196, v196
    v_mfma_f32_16x16x32_bf16 v[32:35], a[192:195], v[212:215], v[32:35]
    v_add_f32 v218, v218, v195
    v_cvt_pk_bf16_f32 v209, v194, v195
    v_mfma_f32_16x16x32_bf16 v[36:39], a[196:199], v[212:215], v[36:39]
    v_exp_f32 v197, v197
    v_mfma_f32_16x16x32_bf16 v[40:43], a[200:203], v[212:215], v[40:43]
    v_add_f32 v218, v218, v196
    v_mfma_f32_16x16x32_bf16 v[44:47], a[204:207], v[212:215], v[44:47]
    v_exp_f32 v198, v198
    v_mfma_f32_16x16x32_bf16 v[48:51], a[208:211], v[212:215], v[48:51]
    v_add_f32 v218, v218, v197
    v_cvt_pk_bf16_f32 v210, v196, v197
    v_mfma_f32_16x16x32_bf16 v[52:55], a[212:215], v[212:215], v[52:55]
    v_exp_f32 v199, v199
    v_mfma_f32_16x16x32_bf16 v[56:59], a[216:219], v[212:215], v[56:59]
    v_add_f32 v218, v218, v198
    v_mfma_f32_16x16x32_bf16 v[60:63], a[220:223], v[212:215], v[60:63]
    v_add_f32 v218, v218, v199
    v_cvt_pk_bf16_f32 v211, v198, v199
    s_waitcnt lgkmcnt(0)
    v_lshlrev_b32 v232, 16, v160
    v_and_b32 v233, s26, v160
    v_pk_mul_f32 v[232:233], v[232:233], v[228:229]
    v_cvt_pk_bf16_f32 v232, v232, v233
    v_accvgpr_write_b32 a48, v232
    v_lshlrev_b32 v234, 16, v161
    v_and_b32 v235, s26, v161
    v_pk_mul_f32 v[234:235], v[234:235], v[228:229]
    v_cvt_pk_bf16_f32 v234, v234, v235
    v_accvgpr_write_b32 a49, v234
    v_lshlrev_b32 v232, 16, v162
    v_and_b32 v233, s26, v162
    v_pk_mul_f32 v[232:233], v[232:233], v[228:229]
    v_cvt_pk_bf16_f32 v232, v232, v233
    v_accvgpr_write_b32 a50, v232
    v_lshlrev_b32 v234, 16, v163
    v_and_b32 v235, s26, v163
    v_pk_mul_f32 v[234:235], v[234:235], v[228:229]
    v_cvt_pk_bf16_f32 v234, v234, v235
    v_accvgpr_write_b32 a51, v234
    v_lshlrev_b32 v232, 16, v164
    v_and_b32 v233, s26, v164
    v_pk_mul_f32 v[232:233], v[232:233], v[228:229]
    v_cvt_pk_bf16_f32 v232, v232, v233
    v_accvgpr_write_b32 a52, v232
    v_lshlrev_b32 v234, 16, v165
    v_and_b32 v235, s26, v165
    v_pk_mul_f32 v[234:235], v[234:235], v[228:229]
    v_cvt_pk_bf16_f32 v234, v234, v235
    v_accvgpr_write_b32 a53, v234
    v_lshlrev_b32 v232, 16, v166
    v_and_b32 v233, s26, v166
    v_pk_mul_f32 v[232:233], v[232:233], v[228:229]
    v_cvt_pk_bf16_f32 v232, v232, v233
    v_accvgpr_write_b32 a54, v232
    v_lshlrev_b32 v234, 16, v167
    v_and_b32 v235, s26, v167
    v_pk_mul_f32 v[234:235], v[234:235], v[228:229]
    v_cvt_pk_bf16_f32 v234, v234, v235
    v_accvgpr_write_b32 a55, v234
    v_lshlrev_b32 v232, 16, v168
    v_and_b32 v233, s26, v168
    v_pk_mul_f32 v[232:233], v[232:233], v[228:229]
    v_cvt_pk_bf16_f32 v232, v232, v233
    v_accvgpr_write_b32 a56, v232
    v_lshlrev_b32 v234, 16, v169
    v_and_b32 v235, s26, v169
    v_pk_mul_f32 v[234:235], v[234:235], v[228:229]
    v_cvt_pk_bf16_f32 v234, v234, v235
    v_accvgpr_write_b32 a57, v234
    v_lshlrev_b32 v232, 16, v170
    v_and_b32 v233, s26, v170
    v_pk_mul_f32 v[232:233], v[232:233], v[228:229]
    v_cvt_pk_bf16_f32 v232, v232, v233
    v_accvgpr_write_b32 a58, v232
    v_lshlrev_b32 v234, 16, v171
    v_and_b32 v235, s26, v171
    v_pk_mul_f32 v[234:235], v[234:235], v[228:229]
    v_cvt_pk_bf16_f32 v234, v234, v235
    v_accvgpr_write_b32 a59, v234
    v_lshlrev_b32 v232, 16, v172
    v_and_b32 v233, s26, v172
    v_pk_mul_f32 v[232:233], v[232:233], v[228:229]
    v_cvt_pk_bf16_f32 v232, v232, v233
    v_accvgpr_write_b32 a60, v232
    v_lshlrev_b32 v234, 16, v173
    v_and_b32 v235, s26, v173
    v_pk_mul_f32 v[234:235], v[234:235], v[228:229]
    v_cvt_pk_bf16_f32 v234, v234, v235
    v_accvgpr_write_b32 a61, v234
    v_lshlrev_b32 v232, 16, v174
    v_and_b32 v233, s26, v174
    v_pk_mul_f32 v[232:233], v[232:233], v[228:229]
    v_cvt_pk_bf16_f32 v232, v232, v233
    v_accvgpr_write_b32 a62, v232
    v_lshlrev_b32 v234, 16, v175
    v_and_b32 v235, s26, v175
    v_pk_mul_f32 v[234:235], v[234:235], v[228:229]
    v_cvt_pk_bf16_f32 v234, v234, v235
    v_accvgpr_write_b32 a63, v234
    s_nop 1
    v_mfma_f32_16x16x32_bf16 v[192:195], a[96:99], a[48:51], 0
    v_exp_f32 v200, v200
    v_mfma_f32_16x16x32_bf16 v[192:195], a[100:103], a[52:55], v[192:195]
    v_exp_f32 v201, v201
    s_mov_b32 s22, 16384
    v_mfma_f32_16x16x32_bf16 v[192:195], a[104:107], a[56:59], v[192:195]
    v_add_f32 v218, v218, v200
    v_mfma_f32_16x16x32_bf16 v[192:195], a[108:111], a[60:63], v[192:195]
    v_exp_f32 v202, v202
    s_add_u32 m0, s21, 33792
    v_mfma_f32_16x16x32_bf16 v[196:199], a[124:127], a[60:63], 0
    v_add_f32 v218, v218, v201
    v_cvt_pk_bf16_f32 v248, v200, v201
    s_nop 0
    v_mfma_f32_16x16x32_bf16 v[196:199], a[120:123], a[56:59], v[196:199]
    v_exp_f32 v203, v203
    v_mfma_f32_16x16x32_bf16 v[196:199], a[116:119], a[52:55], v[196:199]
    v_add_f32 v218, v218, v202
    buffer_load_dwordx4 v224, s[8:11], s22 offen nt lds
    v_mfma_f32_16x16x32_bf16 v[196:199], a[112:115], a[48:51], v[196:199]
    v_exp_f32 v204, v204
    buffer_load_dwordx4 v225, s[8:11], s22 offen offset:1056 nt lds
    v_mfma_f32_16x16x32_bf16 v[64:67], a[160:163], v[208:211], 0
    v_add_f32 v218, v218, v203
    v_cvt_pk_bf16_f32 v249, v202, v203
    v_mfma_f32_16x16x32_bf16 v[68:71], a[164:167], v[208:211], 0
    v_exp_f32 v205, v205
    s_mov_b32 s22, 16384
    v_mfma_f32_16x16x32_bf16 v[72:75], a[168:171], v[208:211], 0
    v_add_f32 v218, v218, v204
    v_mfma_f32_16x16x32_bf16 v[76:79], a[172:175], v[208:211], 0
    v_exp_f32 v206, v206
    s_add_u32 m0, s21, 33792
    v_mfma_f32_16x16x32_bf16 v[80:83], a[176:179], v[208:211], 0
    v_add_f32 v218, v218, v205
    v_cvt_pk_bf16_f32 v250, v204, v205
    s_nop 0
    v_mfma_f32_16x16x32_bf16 v[84:87], a[180:183], v[208:211], 0
    v_exp_f32 v207, v207
    v_mfma_f32_16x16x32_bf16 v[88:91], a[184:187], v[208:211], 0
    v_add_f32 v218, v218, v206
    buffer_load_dwordx4 v224, s[12:15], s22 offen offset:2112 nt lds
    v_mfma_f32_16x16x32_bf16 v[92:95], a[188:191], v[208:211], 0
    v_add_f32 v218, v218, v207
    v_cvt_pk_bf16_f32 v251, v206, v207
    buffer_load_dwordx4 v225, s[12:15], s22 offen offset:3168 nt lds
    s_waitcnt vmcnt(8)
    ds_read_b128 v[160:163], v240 offset:0
    ds_read_b128 v[164:167], v240 offset:256
    ds_read_b128 v[168:171], v240 offset:512
    ds_read_b128 v[172:175], v240 offset:768
    v_mfma_f32_16x16x32_bf16 v[200:203], a[128:131], a[48:51], 0
    v_exp_f32 v192, v192
    v_mfma_f32_16x16x32_bf16 v[200:203], a[132:135], a[52:55], v[200:203]
    v_exp_f32 v193, v193
    v_mfma_f32_16x16x32_bf16 v[200:203], a[136:139], a[56:59], v[200:203]
    v_add_f32 v219, v219, v192
    v_mfma_f32_16x16x32_bf16 v[200:203], a[140:143], a[60:63], v[200:203]
    v_exp_f32 v194, v194
    v_mfma_f32_16x16x32_bf16 v[204:207], a[156:159], a[60:63], 0
    v_add_f32 v219, v219, v193
    v_cvt_pk_bf16_f32 v208, v192, v193
    v_mfma_f32_16x16x32_bf16 v[204:207], a[152:155], a[56:59], v[204:207]
    v_exp_f32 v195, v195
    v_mfma_f32_16x16x32_bf16 v[204:207], a[148:151], a[52:55], v[204:207]
    v_add_f32 v219, v219, v194
    v_mfma_f32_16x16x32_bf16 v[204:207], a[144:147], a[48:51], v[204:207]
    v_exp_f32 v196, v196
    v_add_f32 v219, v219, v195
    v_cvt_pk_bf16_f32 v209, v194, v195
    v_exp_f32 v197, v197
    v_add_f32 v219, v219, v196
    v_exp_f32 v198, v198
    v_add_f32 v219, v219, v197
    v_cvt_pk_bf16_f32 v210, v196, v197
    v_exp_f32 v199, v199
    v_add_f32 v219, v219, v198
    v_add_f32 v219, v219, v199
    v_cvt_pk_bf16_f32 v211, v198, v199
    s_waitcnt lgkmcnt(0)
    v_lshlrev_b32 v232, 16, v160
    v_and_b32 v233, s26, v160
    v_pk_mul_f32 v[232:233], v[232:233], v[228:229]
    v_cvt_pk_bf16_f32 v232, v232, v233
    v_accvgpr_write_b32 a64, v232
    v_lshlrev_b32 v234, 16, v161
    v_and_b32 v235, s26, v161
    v_pk_mul_f32 v[234:235], v[234:235], v[228:229]
    v_cvt_pk_bf16_f32 v234, v234, v235
    v_accvgpr_write_b32 a65, v234
    v_lshlrev_b32 v232, 16, v162
    v_and_b32 v233, s26, v162
    v_pk_mul_f32 v[232:233], v[232:233], v[228:229]
    v_cvt_pk_bf16_f32 v232, v232, v233
    v_accvgpr_write_b32 a66, v232
    v_lshlrev_b32 v234, 16, v163
    v_and_b32 v235, s26, v163
    v_pk_mul_f32 v[234:235], v[234:235], v[228:229]
    v_cvt_pk_bf16_f32 v234, v234, v235
    v_accvgpr_write_b32 a67, v234
    v_lshlrev_b32 v232, 16, v164
    v_and_b32 v233, s26, v164
    v_pk_mul_f32 v[232:233], v[232:233], v[228:229]
    v_cvt_pk_bf16_f32 v232, v232, v233
    v_accvgpr_write_b32 a68, v232
    v_lshlrev_b32 v234, 16, v165
    v_and_b32 v235, s26, v165
    v_pk_mul_f32 v[234:235], v[234:235], v[228:229]
    v_cvt_pk_bf16_f32 v234, v234, v235
    v_accvgpr_write_b32 a69, v234
    v_lshlrev_b32 v232, 16, v166
    v_and_b32 v233, s26, v166
    v_pk_mul_f32 v[232:233], v[232:233], v[228:229]
    v_cvt_pk_bf16_f32 v232, v232, v233
    v_accvgpr_write_b32 a70, v232
    v_lshlrev_b32 v234, 16, v167
    v_and_b32 v235, s26, v167
    v_pk_mul_f32 v[234:235], v[234:235], v[228:229]
    v_cvt_pk_bf16_f32 v234, v234, v235
    v_accvgpr_write_b32 a71, v234
    v_lshlrev_b32 v232, 16, v168
    v_and_b32 v233, s26, v168
    v_pk_mul_f32 v[232:233], v[232:233], v[228:229]
    v_cvt_pk_bf16_f32 v232, v232, v233
    v_accvgpr_write_b32 a72, v232
    v_lshlrev_b32 v234, 16, v169
    v_and_b32 v235, s26, v169
    v_pk_mul_f32 v[234:235], v[234:235], v[228:229]
    v_cvt_pk_bf16_f32 v234, v234, v235
    v_accvgpr_write_b32 a73, v234
    v_lshlrev_b32 v232, 16, v170
    v_and_b32 v233, s26, v170
    v_pk_mul_f32 v[232:233], v[232:233], v[228:229]
    v_cvt_pk_bf16_f32 v232, v232, v233
    v_accvgpr_write_b32 a74, v232
    v_lshlrev_b32 v234, 16, v171
    v_and_b32 v235, s26, v171
    v_pk_mul_f32 v[234:235], v[234:235], v[228:229]
    v_cvt_pk_bf16_f32 v234, v234, v235
    v_accvgpr_write_b32 a75, v234
    v_lshlrev_b32 v232, 16, v172
    v_and_b32 v233, s26, v172
    v_pk_mul_f32 v[232:233], v[232:233], v[228:229]
    v_cvt_pk_bf16_f32 v232, v232, v233
    v_accvgpr_write_b32 a76, v232
    v_lshlrev_b32 v234, 16, v173
    v_and_b32 v235, s26, v173
    v_pk_mul_f32 v[234:235], v[234:235], v[228:229]
    v_cvt_pk_bf16_f32 v234, v234, v235
    v_accvgpr_write_b32 a77, v234
    v_lshlrev_b32 v232, 16, v174
    v_and_b32 v233, s26, v174
    v_pk_mul_f32 v[232:233], v[232:233], v[228:229]
    v_cvt_pk_bf16_f32 v232, v232, v233
    v_accvgpr_write_b32 a78, v232
    v_lshlrev_b32 v234, 16, v175
    v_and_b32 v235, s26, v175
    v_pk_mul_f32 v[234:235], v[234:235], v[228:229]
    v_cvt_pk_bf16_f32 v234, v234, v235
    v_accvgpr_write_b32 a79, v234
    s_nop 1
    v_mfma_f32_16x16x32_bf16 v[192:195], a[96:99], a[64:67], 0
    v_exp_f32 v200, v200
    v_mfma_f32_16x16x32_bf16 v[192:195], a[100:103], a[68:71], v[192:195]
    v_exp_f32 v201, v201
    s_mov_b32 s22, 24576
    v_mfma_f32_16x16x32_bf16 v[192:195], a[104:107], a[72:75], v[192:195]
    v_add_f32 v219, v219, v200
    v_mfma_f32_16x16x32_bf16 v[192:195], a[108:111], a[76:79], v[192:195]
    v_exp_f32 v202, v202
    s_add_u32 m0, s21, 50688
    v_mfma_f32_16x16x32_bf16 v[196:199], a[124:127], a[76:79], 0
    v_add_f32 v219, v219, v201
    v_cvt_pk_bf16_f32 v212, v200, v201
    s_nop 0
    v_mfma_f32_16x16x32_bf16 v[196:199], a[120:123], a[72:75], v[196:199]
    v_exp_f32 v203, v203
    v_mfma_f32_16x16x32_bf16 v[196:199], a[116:119], a[68:71], v[196:199]
    v_add_f32 v219, v219, v202
    buffer_load_dwordx4 v224, s[8:11], s22 offen nt lds
    v_mfma_f32_16x16x32_bf16 v[196:199], a[112:115], a[64:67], v[196:199]
    v_exp_f32 v204, v204
    buffer_load_dwordx4 v225, s[8:11], s22 offen offset:1056 nt lds
    v_mfma_f32_16x16x32_bf16 v[96:99], a[160:163], v[208:211], 0
    v_add_f32 v219, v219, v203
    v_cvt_pk_bf16_f32 v213, v202, v203
    v_mfma_f32_16x16x32_bf16 v[100:103], a[164:167], v[208:211], 0
    v_exp_f32 v205, v205
    s_mov_b32 s22, 24576
    v_mfma_f32_16x16x32_bf16 v[104:107], a[168:171], v[208:211], 0
    v_add_f32 v219, v219, v204
    v_mfma_f32_16x16x32_bf16 v[108:111], a[172:175], v[208:211], 0
    v_exp_f32 v206, v206
    s_add_u32 m0, s21, 50688
    v_mfma_f32_16x16x32_bf16 v[112:115], a[176:179], v[208:211], 0
    v_add_f32 v219, v219, v205
    v_cvt_pk_bf16_f32 v214, v204, v205
    s_nop 0
    v_mfma_f32_16x16x32_bf16 v[116:119], a[180:183], v[208:211], 0
    v_exp_f32 v207, v207
    v_mfma_f32_16x16x32_bf16 v[120:123], a[184:187], v[208:211], 0
    v_add_f32 v219, v219, v206
    buffer_load_dwordx4 v224, s[12:15], s22 offen offset:2112 nt lds
    v_mfma_f32_16x16x32_bf16 v[124:127], a[188:191], v[208:211], 0
    v_add_f32 v219, v219, v207
    v_cvt_pk_bf16_f32 v215, v206, v207
    buffer_load_dwordx4 v225, s[12:15], s22 offen offset:3168 nt lds
    s_waitcnt vmcnt(8)
    ds_read_b128 v[176:179], v240 offset:4352
    ds_read_b128 v[180:183], v240 offset:4608
    ds_read_b128 v[184:187], v240 offset:4864
    ds_read_b128 v[188:191], v240 offset:5120
    v_mfma_f32_16x16x32_bf16 v[200:203], a[128:131], a[64:67], 0
    v_exp_f32 v192, v192
    v_mfma_f32_16x16x32_bf16 v[200:203], a[132:135], a[68:71], v[200:203]
    v_exp_f32 v193, v193
    v_mfma_f32_16x16x32_bf16 v[200:203], a[136:139], a[72:75], v[200:203]
    v_add_f32 v220, v220, v192
    v_mfma_f32_16x16x32_bf16 v[200:203], a[140:143], a[76:79], v[200:203]
    v_exp_f32 v194, v194
    v_mfma_f32_16x16x32_bf16 v[204:207], a[156:159], a[76:79], 0
    v_add_f32 v220, v220, v193
    v_cvt_pk_bf16_f32 v208, v192, v193
    v_mfma_f32_16x16x32_bf16 v[204:207], a[152:155], a[72:75], v[204:207]
    v_exp_f32 v195, v195
    v_mfma_f32_16x16x32_bf16 v[204:207], a[148:151], a[68:71], v[204:207]
    v_add_f32 v220, v220, v194
    v_mfma_f32_16x16x32_bf16 v[204:207], a[144:147], a[64:67], v[204:207]
    v_exp_f32 v196, v196
    v_mfma_f32_16x16x32_bf16 v[96:99], a[192:195], v[212:215], v[96:99]
    v_add_f32 v220, v220, v195
    v_cvt_pk_bf16_f32 v209, v194, v195
    v_mfma_f32_16x16x32_bf16 v[100:103], a[196:199], v[212:215], v[100:103]
    v_exp_f32 v197, v197
    v_mfma_f32_16x16x32_bf16 v[104:107], a[200:203], v[212:215], v[104:107]
    v_add_f32 v220, v220, v196
    v_mfma_f32_16x16x32_bf16 v[108:111], a[204:207], v[212:215], v[108:111]
    v_exp_f32 v198, v198
    v_mfma_f32_16x16x32_bf16 v[112:115], a[208:211], v[212:215], v[112:115]
    v_add_f32 v220, v220, v197
    v_cvt_pk_bf16_f32 v210, v196, v197
    v_mfma_f32_16x16x32_bf16 v[116:119], a[212:215], v[212:215], v[116:119]
    v_exp_f32 v199, v199
    v_mfma_f32_16x16x32_bf16 v[120:123], a[216:219], v[212:215], v[120:123]
    v_add_f32 v220, v220, v198
    v_mfma_f32_16x16x32_bf16 v[124:127], a[220:223], v[212:215], v[124:127]
    v_add_f32 v220, v220, v199
    v_cvt_pk_bf16_f32 v211, v198, v199
    s_waitcnt lgkmcnt(0)
    v_lshlrev_b32 v232, 16, v176
    v_and_b32 v233, s26, v176
    v_pk_mul_f32 v[232:233], v[232:233], v[228:229]
    v_cvt_pk_bf16_f32 v232, v232, v233
    v_accvgpr_write_b32 a80, v232
    v_lshlrev_b32 v234, 16, v177
    v_and_b32 v235, s26, v177
    v_pk_mul_f32 v[234:235], v[234:235], v[228:229]
    v_cvt_pk_bf16_f32 v234, v234, v235
    v_accvgpr_write_b32 a81, v234
    v_lshlrev_b32 v232, 16, v178
    v_and_b32 v233, s26, v178
    v_pk_mul_f32 v[232:233], v[232:233], v[228:229]
    v_cvt_pk_bf16_f32 v232, v232, v233
    v_accvgpr_write_b32 a82, v232
    v_lshlrev_b32 v234, 16, v179
    v_and_b32 v235, s26, v179
    v_pk_mul_f32 v[234:235], v[234:235], v[228:229]
    v_cvt_pk_bf16_f32 v234, v234, v235
    v_accvgpr_write_b32 a83, v234
    v_lshlrev_b32 v232, 16, v180
    v_and_b32 v233, s26, v180
    v_pk_mul_f32 v[232:233], v[232:233], v[228:229]
    v_cvt_pk_bf16_f32 v232, v232, v233
    v_accvgpr_write_b32 a84, v232
    v_lshlrev_b32 v234, 16, v181
    v_and_b32 v235, s26, v181
    v_pk_mul_f32 v[234:235], v[234:235], v[228:229]
    v_cvt_pk_bf16_f32 v234, v234, v235
    v_accvgpr_write_b32 a85, v234
    v_lshlrev_b32 v232, 16, v182
    v_and_b32 v233, s26, v182
    v_pk_mul_f32 v[232:233], v[232:233], v[228:229]
    v_cvt_pk_bf16_f32 v232, v232, v233
    v_accvgpr_write_b32 a86, v232
    v_lshlrev_b32 v234, 16, v183
    v_and_b32 v235, s26, v183
    v_pk_mul_f32 v[234:235], v[234:235], v[228:229]
    v_cvt_pk_bf16_f32 v234, v234, v235
    v_accvgpr_write_b32 a87, v234
    v_lshlrev_b32 v232, 16, v184
    v_and_b32 v233, s26, v184
    v_pk_mul_f32 v[232:233], v[232:233], v[228:229]
    v_cvt_pk_bf16_f32 v232, v232, v233
    v_accvgpr_write_b32 a88, v232
    v_lshlrev_b32 v234, 16, v185
    v_and_b32 v235, s26, v185
    v_pk_mul_f32 v[234:235], v[234:235], v[228:229]
    v_cvt_pk_bf16_f32 v234, v234, v235
    v_accvgpr_write_b32 a89, v234
    v_lshlrev_b32 v232, 16, v186
    v_and_b32 v233, s26, v186
    v_pk_mul_f32 v[232:233], v[232:233], v[228:229]
    v_cvt_pk_bf16_f32 v232, v232, v233
    v_accvgpr_write_b32 a90, v232
    v_lshlrev_b32 v234, 16, v187
    v_and_b32 v235, s26, v187
    v_pk_mul_f32 v[234:235], v[234:235], v[228:229]
    v_cvt_pk_bf16_f32 v234, v234, v235
    v_accvgpr_write_b32 a91, v234
    v_lshlrev_b32 v232, 16, v188
    v_and_b32 v233, s26, v188
    v_pk_mul_f32 v[232:233], v[232:233], v[228:229]
    v_cvt_pk_bf16_f32 v232, v232, v233
    v_accvgpr_write_b32 a92, v232
    v_lshlrev_b32 v234, 16, v189
    v_and_b32 v235, s26, v189
    v_pk_mul_f32 v[234:235], v[234:235], v[228:229]
    v_cvt_pk_bf16_f32 v234, v234, v235
    v_accvgpr_write_b32 a93, v234
    v_lshlrev_b32 v232, 16, v190
    v_and_b32 v233, s26, v190
    v_pk_mul_f32 v[232:233], v[232:233], v[228:229]
    v_cvt_pk_bf16_f32 v232, v232, v233
    v_accvgpr_write_b32 a94, v232
    v_lshlrev_b32 v234, 16, v191
    v_and_b32 v235, s26, v191
    v_pk_mul_f32 v[234:235], v[234:235], v[228:229]
    v_cvt_pk_bf16_f32 v234, v234, v235
    v_accvgpr_write_b32 a95, v234
    s_nop 1
    s_waitcnt vmcnt(6)
    s_barrier
    v_mfma_f32_16x16x32_bf16 v[192:195], a[96:99], a[80:83], 0
    v_exp_f32 v200, v200
    v_add_u32 v228, 50688, v222
    v_mfma_f32_16x16x32_bf16 v[192:195], a[100:103], a[84:87], v[192:195]
    v_exp_f32 v201, v201
    v_add_u32 v229, 50688, v223
    v_mfma_f32_16x16x32_bf16 v[192:195], a[104:107], a[88:91], v[192:195]
    v_add_f32 v220, v220, v200
    v_mov_b32 v160, 0
    v_mfma_f32_16x16x32_bf16 v[192:195], a[108:111], a[92:95], v[192:195]
    v_exp_f32 v202, v202
    v_mov_b32 v161, 0
    v_mfma_f32_16x16x32_bf16 v[196:199], a[124:127], a[92:95], 0
    v_add_f32 v220, v220, v201
    v_cvt_pk_bf16_f32 v252, v200, v201
    v_mov_b32 v162, 0
    v_mfma_f32_16x16x32_bf16 v[196:199], a[120:123], a[88:91], v[196:199]
    v_exp_f32 v203, v203
    v_mov_b32 v163, 0
    v_mfma_f32_16x16x32_bf16 v[196:199], a[116:119], a[84:87], v[196:199]
    v_add_f32 v220, v220, v202
    v_mov_b32 v164, 0
    v_mfma_f32_16x16x32_bf16 v[196:199], a[112:115], a[80:83], v[196:199]
    v_exp_f32 v204, v204
    v_mov_b32 v165, 0
    v_mov_b32 v166, 0
    v_mfma_f32_16x16x32_bf16 v[128:131], a[160:163], v[208:211], 0
    v_add_f32 v220, v220, v203
    v_cvt_pk_bf16_f32 v253, v202, v203
    v_mov_b32 v167, 0
    v_mfma_f32_16x16x32_bf16 v[132:135], a[164:167], v[208:211], 0
    v_exp_f32 v205, v205
    v_mov_b32 v168, 0
    v_mfma_f32_16x16x32_bf16 v[136:139], a[168:171], v[208:211], 0
    ds_read_b128 a[96:99], v222 offset:33792
    v_add_f32 v220, v220, v204
    v_mov_b32 v169, 0
    v_mfma_f32_16x16x32_bf16 v[140:143], a[172:175], v[208:211], 0
    v_exp_f32 v206, v206
    v_mov_b32 v170, 0
    v_mfma_f32_16x16x32_bf16 v[144:147], a[176:179], v[208:211], 0
    v_add_f32 v220, v220, v205
    v_cvt_pk_bf16_f32 v254, v204, v205
    v_mov_b32 v171, 0
    v_mfma_f32_16x16x32_bf16 v[148:151], a[180:183], v[208:211], 0
    v_exp_f32 v207, v207
    v_mov_b32 v172, 0
    v_mfma_f32_16x16x32_bf16 v[152:155], a[184:187], v[208:211], 0
    ds_read_b128 a[100:103], v222 offset:34048
    v_add_f32 v220, v220, v206
    v_mov_b32 v173, 0
    v_mfma_f32_16x16x32_bf16 v[156:159], a[188:191], v[208:211], 0
    v_add_f32 v220, v220, v207
    v_cvt_pk_bf16_f32 v255, v206, v207
    v_mov_b32 v174, 0
    v_mov_b32 v175, 0
    v_mfma_f32_16x16x32_bf16 v[200:203], a[128:131], a[80:83], 0
    v_exp_f32 v192, v192
    v_mfma_f32_16x16x32_bf16 v[200:203], a[132:135], a[84:87], v[200:203]
    ds_read_b128 a[120:123], v222 offset:42752
    v_exp_f32 v193, v193
    s_mov_b32 s22, 32768
    v_mfma_f32_16x16x32_bf16 v[200:203], a[136:139], a[88:91], v[200:203]
    ds_read_b128 a[104:107], v222 offset:34304
    v_add_f32 v221, v221, v192
    v_mfma_f32_16x16x32_bf16 v[200:203], a[140:143], a[92:95], v[200:203]
    ds_read_b128 a[124:127], v222 offset:43008
    v_exp_f32 v194, v194
    s_add_u32 m0, s21, 67584
    v_mfma_f32_16x16x32_bf16 v[204:207], a[156:159], a[92:95], 0
    v_add_f32 v221, v221, v193
    v_cvt_pk_bf16_f32 v240, v192, v193
    s_nop 0
    v_mfma_f32_16x16x32_bf16 v[204:207], a[152:155], a[88:91], v[204:207]
    v_exp_f32 v195, v195
    v_mfma_f32_16x16x32_bf16 v[204:207], a[148:151], a[84:87], v[204:207]
    ds_read_b128 a[108:111], v222 offset:34560
    v_add_f32 v221, v221, v194
    buffer_load_dwordx4 v224, s[8:11], s22 offen nt lds
    v_mfma_f32_16x16x32_bf16 v[204:207], a[144:147], a[80:83], v[204:207]
    v_exp_f32 v196, v196
    buffer_load_dwordx4 v225, s[8:11], s22 offen offset:1056 nt lds
    v_add_f32 v221, v221, v195
    v_cvt_pk_bf16_f32 v241, v194, v195
    v_exp_f32 v197, v197
    s_mov_b32 s22, 32768
    ds_read_b128 a[112:115], v222 offset:42240
    v_add_f32 v221, v221, v196
    v_exp_f32 v198, v198
    s_add_u32 m0, s21, 67584
    v_add_f32 v221, v221, v197
    v_cvt_pk_bf16_f32 v242, v196, v197
    s_nop 0
    v_exp_f32 v199, v199
    ds_read_b128 a[116:119], v222 offset:42496
    v_add_f32 v221, v221, v198
    buffer_load_dwordx4 v224, s[12:15], s22 offen offset:2112 nt lds
    v_add_f32 v221, v221, v199
    v_cvt_pk_bf16_f32 v243, v198, v199
    buffer_load_dwordx4 v225, s[12:15], s22 offen offset:3168 nt lds
    s_waitcnt vmcnt(8)
    s_waitcnt lgkmcnt(0)
    s_barrier
    v_mfma_f32_16x16x32_bf16 v[192:195], a[96:99], a[0:3], 0
    v_exp_f32 v200, v200
    ds_read_b64_tr_b16 a[224:225], v223 offset:33792
    v_mfma_f32_16x16x32_bf16 v[192:195], a[100:103], a[4:7], v[192:195]
    v_exp_f32 v201, v201
    ds_read_b64_tr_b16 a[226:227], v223 offset:42240
    v_mfma_f32_16x16x32_bf16 v[192:195], a[104:107], a[8:11], v[192:195]
    v_add_f32 v221, v221, v200
    ds_read_b64_tr_b16 a[228:229], v223 offset:33824
    v_mfma_f32_16x16x32_bf16 v[192:195], a[108:111], a[12:15], v[192:195]
    v_exp_f32 v202, v202
    ds_read_b64_tr_b16 a[230:231], v223 offset:42272
    v_mfma_f32_16x16x32_bf16 v[196:199], a[124:127], a[12:15], 0
    v_add_f32 v221, v221, v201
    v_cvt_pk_bf16_f32 v212, v200, v201
    ds_read_b64_tr_b16 a[232:233], v223 offset:34048
    v_mfma_f32_16x16x32_bf16 v[196:199], a[120:123], a[8:11], v[196:199]
    v_exp_f32 v203, v203
    ds_read_b64_tr_b16 a[234:235], v223 offset:42496
    v_mfma_f32_16x16x32_bf16 v[196:199], a[116:119], a[4:7], v[196:199]
    v_add_f32 v221, v221, v202
    ds_read_b64_tr_b16 a[236:237], v223 offset:34080
    v_mfma_f32_16x16x32_bf16 v[196:199], a[112:115], a[0:3], v[196:199]
    v_exp_f32 v204, v204
    ds_read_b64_tr_b16 a[238:239], v223 offset:42528
    v_add_f32 v221, v221, v203
    v_cvt_pk_bf16_f32 v213, v202, v203
    ds_read_b64_tr_b16 a[240:241], v223 offset:34304
    v_exp_f32 v205, v205
    ds_read_b64_tr_b16 a[242:243], v223 offset:42752
    v_add_f32 v221, v221, v204
    ds_read_b64_tr_b16 a[244:245], v223 offset:34336
    v_exp_f32 v206, v206
    ds_read_b64_tr_b16 a[246:247], v223 offset:42784
    v_add_f32 v221, v221, v205
    v_cvt_pk_bf16_f32 v214, v204, v205
    ds_read_b64_tr_b16 a[248:249], v223 offset:34560
    v_exp_f32 v207, v207
    ds_read_b64_tr_b16 a[250:251], v223 offset:43008
    v_add_f32 v221, v221, v206
    ds_read_b64_tr_b16 a[252:253], v223 offset:34592
    v_add_f32 v221, v221, v207
    v_cvt_pk_bf16_f32 v215, v206, v207
    ds_read_b64_tr_b16 a[254:255], v223 offset:43040
    s_nop 1
    v_mfma_f32_16x16x32_bf16 v[188:191], a[188:191], v[240:243], 0
    v_mfma_f32_16x16x32_bf16 v[188:191], a[220:223], v[212:215], v[188:191]
    v_mfma_f32_16x16x32_bf16 v[184:187], a[184:187], v[240:243], 0
    v_mfma_f32_16x16x32_bf16 v[184:187], a[216:219], v[212:215], v[184:187]
    v_mfma_f32_16x16x32_bf16 v[180:183], a[180:183], v[240:243], 0
    v_mfma_f32_16x16x32_bf16 v[180:183], a[212:215], v[212:215], v[180:183]
    v_mfma_f32_16x16x32_bf16 v[176:179], a[176:179], v[240:243], 0
    v_mfma_f32_16x16x32_bf16 v[176:179], a[208:211], v[212:215], v[176:179]
    s_mov_b32 s22, 40960
    s_mov_b32 s23, 10
    .p2align 6
L_loop:
    v_mfma_f32_16x16x32_bf16 v[204:207], a[112:115], a[16:19], 0
    s_waitcnt vmcnt(4)
    s_barrier
    v_exp_f32 v192, v192
    v_mfma_f32_16x16x32_bf16 v[204:207], a[116:119], a[20:23], v[204:207]
    s_add_u32 m0, s21, 84480
    v_exp_f32 v193, v193
    v_mfma_f32_16x16x32_bf16 v[204:207], a[120:123], a[24:27], v[204:207]
    ds_read_b128 a[128:131], v228 offset:0
    v_add_f32 v216, v216, v192
    v_mfma_f32_16x16x32_bf16 v[204:207], a[124:127], a[28:31], v[204:207]
    buffer_load_dwordx4 v224, s[8:11], s22 offen nt lds
    v_exp_f32 v194, v194
    v_mfma_f32_16x16x32_bf16 v[200:203], a[108:111], a[28:31], 0
    v_add_f32 v216, v216, v193
    v_cvt_pk_bf16_f32 v208, v192, v193
    v_mfma_f32_16x16x32_bf16 v[200:203], a[104:107], a[24:27], v[200:203]
    v_exp_f32 v195, v195
    v_mfma_f32_16x16x32_bf16 v[200:203], a[100:103], a[20:23], v[200:203]
    ds_read_b128 a[132:135], v228 offset:256
    v_add_f32 v216, v216, v194
    v_mfma_f32_16x16x32_bf16 v[200:203], a[96:99], a[16:19], v[200:203]
    v_exp_f32 v196, v196
    v_mfma_f32_16x16x32_bf16 v[172:175], a[172:175], v[240:243], v[172:175]
    v_add_f32 v216, v216, v195
    v_cvt_pk_bf16_f32 v209, v194, v195
    v_mfma_f32_16x16x32_bf16 v[172:175], a[204:207], v[212:215], v[172:175]
    v_exp_f32 v197, v197
    v_mfma_f32_16x16x32_bf16 v[168:171], a[168:171], v[240:243], v[168:171]
    ds_read_b128 a[136:139], v228 offset:512
    v_add_f32 v216, v216, v196
    v_mfma_f32_16x16x32_bf16 v[168:171], a[200:203], v[212:215], v[168:171]
    v_exp_f32 v198, v198
    v_mfma_f32_16x16x32_bf16 v[164:167], a[164:167], v[240:243], v[164:167]
    v_add_f32 v216, v216, v197
    v_cvt_pk_bf16_f32 v210, v196, v197
    v_mfma_f32_16x16x32_bf16 v[164:167], a[196:199], v[212:215], v[164:167]
    v_exp_f32 v199, v199
    v_mfma_f32_16x16x32_bf16 v[160:163], a[160:163], v[240:243], v[160:163]
    v_cvt_pk_bf16_f32 v211, v198, v199
    v_add_f32 v216, v216, v198
    v_mfma_f32_16x16x32_bf16 v[160:163], a[192:195], v[212:215], v[160:163]
    s_waitcnt lgkmcnt(3)
    ds_read_b128 a[140:143], v228 offset:768
    v_add_f32 v216, v216, v199
    v_mfma_f32_16x16x32_bf16 v[0:3], a[192:195], v[244:247], v[0:3]
    v_exp_f32 v200, v200
    v_mfma_f32_16x16x32_bf16 v[0:3], a[224:227], v[208:211], v[0:3]
    v_exp_f32 v201, v201
    v_mfma_f32_16x16x32_bf16 v[4:7], a[196:199], v[244:247], v[4:7]
    ds_read_b128 a[144:147], v228 offset:8448
    v_add_f32 v217, v217, v200
    v_mfma_f32_16x16x32_bf16 v[4:7], a[228:231], v[208:211], v[4:7]
    buffer_load_dwordx4 v225, s[8:11], s22 offen offset:1056 nt lds
    v_exp_f32 v202, v202
    v_mfma_f32_16x16x32_bf16 v[8:11], a[200:203], v[244:247], v[8:11]
    v_add_f32 v217, v217, v201
    v_cvt_pk_bf16_f32 v232, v200, v201
    v_mfma_f32_16x16x32_bf16 v[8:11], a[232:235], v[208:211], v[8:11]
    v_exp_f32 v203, v203
    v_mfma_f32_16x16x32_bf16 v[12:15], a[204:207], v[244:247], v[12:15]
    ds_read_b64_tr_b16 a[160:161], v229 offset:0
    v_add_f32 v217, v217, v202
    v_mfma_f32_16x16x32_bf16 v[12:15], a[236:239], v[208:211], v[12:15]
    v_exp_f32 v204, v204
    v_mfma_f32_16x16x32_bf16 v[192:195], a[96:99], a[32:35], 0
    v_add_f32 v217, v217, v203
    v_cvt_pk_bf16_f32 v233, v202, v203
    v_mfma_f32_16x16x32_bf16 v[192:195], a[100:103], a[36:39], v[192:195]
    v_exp_f32 v205, v205
    v_mfma_f32_16x16x32_bf16 v[192:195], a[104:107], a[40:43], v[192:195]
    ds_read_b64_tr_b16 a[162:163], v229 offset:8448
    v_add_f32 v217, v217, v204
    v_mfma_f32_16x16x32_bf16 v[192:195], a[108:111], a[44:47], v[192:195]
    v_exp_f32 v206, v206
    v_mfma_f32_16x16x32_bf16 v[196:199], a[124:127], a[44:47], 0
    v_add_f32 v217, v217, v205
    v_cvt_pk_bf16_f32 v234, v204, v205
    v_mfma_f32_16x16x32_bf16 v[196:199], a[120:123], a[40:43], v[196:199]
    v_exp_f32 v207, v207
    v_mfma_f32_16x16x32_bf16 v[196:199], a[116:119], a[36:39], v[196:199]
    ds_read_b64_tr_b16 a[164:165], v229 offset:32
    v_add_f32 v217, v217, v206
    v_mfma_f32_16x16x32_bf16 v[196:199], a[112:115], a[32:35], v[196:199]
    v_add_f32 v217, v217, v207
    v_cvt_pk_bf16_f32 v235, v206, v207
    v_mfma_f32_16x16x32_bf16 v[204:207], a[112:115], a[48:51], 0
    v_exp_f32 v192, v192
    v_mfma_f32_16x16x32_bf16 v[204:207], a[116:119], a[52:55], v[204:207]
    v_exp_f32 v193, v193
    v_mfma_f32_16x16x32_bf16 v[204:207], a[120:123], a[56:59], v[204:207]
    ds_read_b128 a[148:151], v228 offset:8704
    v_add_f32 v218, v218, v192
    v_mfma_f32_16x16x32_bf16 v[204:207], a[124:127], a[60:63], v[204:207]
    buffer_load_dwordx4 v224, s[12:15], s22 offen offset:2112 nt lds
    v_exp_f32 v194, v194
    v_mfma_f32_16x16x32_bf16 v[200:203], a[108:111], a[60:63], 0
    v_add_f32 v218, v218, v193
    v_cvt_pk_bf16_f32 v212, v192, v193
    v_mfma_f32_16x16x32_bf16 v[200:203], a[104:107], a[56:59], v[200:203]
    v_exp_f32 v195, v195
    v_mfma_f32_16x16x32_bf16 v[200:203], a[100:103], a[52:55], v[200:203]
    ds_read_b64_tr_b16 a[166:167], v229 offset:8480
    v_add_f32 v218, v218, v194
    v_mfma_f32_16x16x32_bf16 v[200:203], a[96:99], a[48:51], v[200:203]
    v_exp_f32 v196, v196
    v_mfma_f32_16x16x32_bf16 v[16:19], a[208:211], v[244:247], v[16:19]
    v_add_f32 v218, v218, v195
    v_cvt_pk_bf16_f32 v213, v194, v195
    v_mfma_f32_16x16x32_bf16 v[16:19], a[240:243], v[208:211], v[16:19]
    v_exp_f32 v197, v197
    v_mfma_f32_16x16x32_bf16 v[20:23], a[212:215], v[244:247], v[20:23]
    ds_read_b64_tr_b16 a[168:169], v229 offset:256
    v_add_f32 v218, v218, v196
    v_mfma_f32_16x16x32_bf16 v[20:23], a[244:247], v[208:211], v[20:23]
    v_exp_f32 v198, v198
    v_mfma_f32_16x16x32_bf16 v[24:27], a[216:219], v[244:247], v[24:27]
    v_add_f32 v218, v218, v197
    v_cvt_pk_bf16_f32 v214, v196, v197
    v_mfma_f32_16x16x32_bf16 v[24:27], a[248:251], v[208:211], v[24:27]
    v_exp_f32 v199, v199
    v_mfma_f32_16x16x32_bf16 v[28:31], a[220:223], v[244:247], v[28:31]
    v_cvt_pk_bf16_f32 v215, v198, v199
    v_add_f32 v218, v218, v198
    v_mfma_f32_16x16x32_bf16 v[28:31], a[252:255], v[208:211], v[28:31]
    ds_read_b64_tr_b16 a[170:171], v229 offset:8704
    v_add_f32 v218, v218, v199
    v_mfma_f32_16x16x32_bf16 v[92:95], a[252:255], v[212:215], v[92:95]
    v_exp_f32 v200, v200
    v_mfma_f32_16x16x32_bf16 v[92:95], a[220:223], v[248:251], v[92:95]
    v_exp_f32 v201, v201
    v_mfma_f32_16x16x32_bf16 v[88:91], a[216:219], v[248:251], v[88:91]
    ds_read_b128 a[152:155], v228 offset:8960
    v_add_f32 v219, v219, v200
    v_mfma_f32_16x16x32_bf16 v[88:91], a[248:251], v[212:215], v[88:91]
    buffer_load_dwordx4 v225, s[12:15], s22 offen offset:3168 nt lds
    v_exp_f32 v202, v202
    v_mfma_f32_16x16x32_bf16 v[84:87], a[212:215], v[248:251], v[84:87]
    v_add_f32 v219, v219, v201
    v_cvt_pk_bf16_f32 v236, v200, v201
    v_mfma_f32_16x16x32_bf16 v[84:87], a[244:247], v[212:215], v[84:87]
    s_add_u32 s22, s22, 8192
    v_exp_f32 v203, v203
    v_mfma_f32_16x16x32_bf16 v[80:83], a[208:211], v[248:251], v[80:83]
    ds_read_b64_tr_b16 a[172:173], v229 offset:288
    v_add_f32 v219, v219, v202
    v_mfma_f32_16x16x32_bf16 v[80:83], a[240:243], v[212:215], v[80:83]
    v_exp_f32 v204, v204
    v_mfma_f32_16x16x32_bf16 v[192:195], a[96:99], a[64:67], 0
    v_add_f32 v219, v219, v203
    v_cvt_pk_bf16_f32 v237, v202, v203
    v_mfma_f32_16x16x32_bf16 v[192:195], a[100:103], a[68:71], v[192:195]
    v_exp_f32 v205, v205
    v_mfma_f32_16x16x32_bf16 v[192:195], a[104:107], a[72:75], v[192:195]
    ds_read_b64_tr_b16 a[174:175], v229 offset:8736
    v_add_f32 v219, v219, v204
    v_mfma_f32_16x16x32_bf16 v[192:195], a[108:111], a[76:79], v[192:195]
    v_exp_f32 v206, v206
    v_mfma_f32_16x16x32_bf16 v[196:199], a[124:127], a[76:79], 0
    v_add_f32 v219, v219, v205
    v_cvt_pk_bf16_f32 v238, v204, v205
    v_mfma_f32_16x16x32_bf16 v[196:199], a[120:123], a[72:75], v[196:199]
    v_exp_f32 v207, v207
    v_mfma_f32_16x16x32_bf16 v[196:199], a[116:119], a[68:71], v[196:199]
    ds_read_b64_tr_b16 a[176:177], v229 offset:512
    v_add_f32 v219, v219, v206
    v_mfma_f32_16x16x32_bf16 v[196:199], a[112:115], a[64:67], v[196:199]
    v_add_f32 v219, v219, v207
    v_cvt_pk_bf16_f32 v239, v206, v207
    v_mfma_f32_16x16x32_bf16 v[204:207], a[112:115], a[80:83], 0
    v_exp_f32 v192, v192
    v_mfma_f32_16x16x32_bf16 v[204:207], a[116:119], a[84:87], v[204:207]
    v_exp_f32 v193, v193
    v_mfma_f32_16x16x32_bf16 v[204:207], a[120:123], a[88:91], v[204:207]
    ds_read_b128 a[156:159], v228 offset:9216
    v_add_f32 v220, v220, v192
    v_mfma_f32_16x16x32_bf16 v[204:207], a[124:127], a[92:95], v[204:207]
    v_exp_f32 v194, v194
    v_mfma_f32_16x16x32_bf16 v[200:203], a[108:111], a[92:95], 0
    v_add_f32 v220, v220, v193
    v_cvt_pk_bf16_f32 v208, v192, v193
    v_mfma_f32_16x16x32_bf16 v[200:203], a[104:107], a[88:91], v[200:203]
    v_exp_f32 v195, v195
    v_mfma_f32_16x16x32_bf16 v[200:203], a[100:103], a[84:87], v[200:203]
    ds_read_b64_tr_b16 a[178:179], v229 offset:8960
    v_add_f32 v220, v220, v194
    v_mfma_f32_16x16x32_bf16 v[200:203], a[96:99], a[80:83], v[200:203]
    v_exp_f32 v196, v196
    v_mfma_f32_16x16x32_bf16 v[76:79], a[204:207], v[248:251], v[76:79]
    v_add_f32 v220, v220, v195
    v_cvt_pk_bf16_f32 v209, v194, v195
    v_mfma_f32_16x16x32_bf16 v[76:79], a[236:239], v[212:215], v[76:79]
    v_exp_f32 v197, v197
    v_mfma_f32_16x16x32_bf16 v[72:75], a[200:203], v[248:251], v[72:75]
    ds_read_b64_tr_b16 a[180:181], v229 offset:544
    v_add_f32 v220, v220, v196
    v_mfma_f32_16x16x32_bf16 v[72:75], a[232:235], v[212:215], v[72:75]
    v_exp_f32 v198, v198
    v_mfma_f32_16x16x32_bf16 v[68:71], a[196:199], v[248:251], v[68:71]
    v_add_f32 v220, v220, v197
    v_cvt_pk_bf16_f32 v210, v196, v197
    v_mfma_f32_16x16x32_bf16 v[68:71], a[228:231], v[212:215], v[68:71]
    v_exp_f32 v199, v199
    v_mfma_f32_16x16x32_bf16 v[64:67], a[192:195], v[248:251], v[64:67]
    v_cvt_pk_bf16_f32 v211, v198, v199
    v_add_f32 v220, v220, v198
    v_mfma_f32_16x16x32_bf16 v[64:67], a[224:227], v[212:215], v[64:67]
    ds_read_b64_tr_b16 a[182:183], v229 offset:8992
    v_add_f32 v220, v220, v199
    v_mfma_f32_16x16x32_bf16 v[128:131], a[224:227], v[208:211], v[128:131]
    v_exp_f32 v200, v200
    v_mfma_f32_16x16x32_bf16 v[128:131], a[192:195], v[252:255], v[128:131]
    v_exp_f32 v201, v201
    v_mfma_f32_16x16x32_bf16 v[132:135], a[196:199], v[252:255], v[132:135]
    ds_read_b64_tr_b16 a[184:185], v229 offset:768
    v_add_f32 v221, v221, v200
    v_mfma_f32_16x16x32_bf16 v[132:135], a[228:231], v[208:211], v[132:135]
    v_exp_f32 v202, v202
    v_mfma_f32_16x16x32_bf16 v[136:139], a[200:203], v[252:255], v[136:139]
    s_waitcnt lgkmcnt(4)
    v_add_f32 v221, v221, v201
    v_cvt_pk_bf16_f32 v240, v200, v201
    v_mfma_f32_16x16x32_bf16 v[136:139], a[232:235], v[208:211], v[136:139]
    v_exp_f32 v203, v203
    v_mfma_f32_16x16x32_bf16 v[140:143], a[204:207], v[252:255], v[140:143]
    ds_read_b64_tr_b16 a[186:187], v229 offset:9216
    v_add_f32 v221, v221, v202
    v_mfma_f32_16x16x32_bf16 v[140:143], a[236:239], v[208:211], v[140:143]
    v_exp_f32 v204, v204
    v_mfma_f32_16x16x32_bf16 v[192:195], a[128:131], a[16:19], 0
    v_add_f32 v221, v221, v203
    v_cvt_pk_bf16_f32 v241, v202, v203
    v_mfma_f32_16x16x32_bf16 v[192:195], a[132:135], a[20:23], v[192:195]
    v_exp_f32 v205, v205
    v_mfma_f32_16x16x32_bf16 v[192:195], a[136:139], a[24:27], v[192:195]
    ds_read_b64_tr_b16 a[188:189], v229 offset:800
    v_add_f32 v221, v221, v204
    v_mfma_f32_16x16x32_bf16 v[192:195], a[140:143], a[28:31], v[192:195]
    v_exp_f32 v206, v206
    v_mfma_f32_16x16x32_bf16 v[196:199], a[156:159], a[28:31], 0
    v_add_f32 v221, v221, v205
    v_cvt_pk_bf16_f32 v242, v204, v205
    v_mfma_f32_16x16x32_bf16 v[196:199], a[152:155], a[24:27], v[196:199]
    v_exp_f32 v207, v207
    v_mfma_f32_16x16x32_bf16 v[196:199], a[148:151], a[20:23], v[196:199]
    ds_read_b64_tr_b16 a[190:191], v229 offset:9248
    v_add_f32 v221, v221, v206
    v_mfma_f32_16x16x32_bf16 v[196:199], a[144:147], a[16:19], v[196:199]
    v_add_f32 v221, v221, v207
    v_cvt_pk_bf16_f32 v243, v206, v207
    v_mfma_f32_16x16x32_bf16 v[204:207], a[144:147], a[0:3], 0
    s_waitcnt vmcnt(4)
    s_barrier
    v_exp_f32 v192, v192
    v_mfma_f32_16x16x32_bf16 v[204:207], a[148:151], a[4:7], v[204:207]
    s_add_u32 m0, s21, 0
    v_exp_f32 v193, v193
    v_mfma_f32_16x16x32_bf16 v[204:207], a[152:155], a[8:11], v[204:207]
    ds_read_b128 a[96:99], v228 offset:16896
    v_add_f32 v217, v217, v192
    v_mfma_f32_16x16x32_bf16 v[204:207], a[156:159], a[12:15], v[204:207]
    buffer_load_dwordx4 v224, s[8:11], s22 offen nt lds
    v_exp_f32 v194, v194
    v_mfma_f32_16x16x32_bf16 v[200:203], a[140:143], a[12:15], 0
    v_add_f32 v217, v217, v193
    v_cvt_pk_bf16_f32 v212, v192, v193
    v_mfma_f32_16x16x32_bf16 v[200:203], a[136:139], a[8:11], v[200:203]
    v_exp_f32 v195, v195
    v_mfma_f32_16x16x32_bf16 v[200:203], a[132:135], a[4:7], v[200:203]
    ds_read_b128 a[100:103], v228 offset:17152
    v_add_f32 v217, v217, v194
    v_mfma_f32_16x16x32_bf16 v[200:203], a[128:131], a[0:3], v[200:203]
    v_exp_f32 v196, v196
    v_mfma_f32_16x16x32_bf16 v[144:147], a[208:211], v[252:255], v[144:147]
    v_add_f32 v217, v217, v195
    v_cvt_pk_bf16_f32 v213, v194, v195
    v_mfma_f32_16x16x32_bf16 v[144:147], a[240:243], v[208:211], v[144:147]
    v_exp_f32 v197, v197
    v_mfma_f32_16x16x32_bf16 v[148:151], a[212:215], v[252:255], v[148:151]
    ds_read_b128 a[104:107], v228 offset:17408
    v_add_f32 v217, v217, v196
    v_mfma_f32_16x16x32_bf16 v[148:151], a[244:247], v[208:211], v[148:151]
    v_exp_f32 v198, v198
    v_mfma_f32_16x16x32_bf16 v[152:155], a[216:219], v[252:255], v[152:155]
    v_add_f32 v217, v217, v197
    v_cvt_pk_bf16_f32 v214, v196, v197
    v_mfma_f32_16x16x32_bf16 v[152:155], a[248:251], v[208:211], v[152:155]
    v_exp_f32 v199, v199
    v_mfma_f32_16x16x32_bf16 v[156:159], a[220:223], v[252:255], v[156:159]
    v_cvt_pk_bf16_f32 v215, v198, v199
    v_add_f32 v217, v217, v198
    v_mfma_f32_16x16x32_bf16 v[156:159], a[252:255], v[208:211], v[156:159]
    s_waitcnt lgkmcnt(3)
    ds_read_b128 a[108:111], v228 offset:17664
    v_add_f32 v217, v217, v199
    v_mfma_f32_16x16x32_bf16 v[60:63], a[252:255], v[232:235], v[60:63]
    v_exp_f32 v200, v200
    v_mfma_f32_16x16x32_bf16 v[60:63], a[188:191], v[212:215], v[60:63]
    v_exp_f32 v201, v201
    v_mfma_f32_16x16x32_bf16 v[56:59], a[248:251], v[232:235], v[56:59]
    ds_read_b128 a[112:115], v228 offset:25344
    v_add_f32 v216, v216, v200
    v_mfma_f32_16x16x32_bf16 v[56:59], a[184:187], v[212:215], v[56:59]
    buffer_load_dwordx4 v225, s[8:11], s22 offen offset:1056 nt lds
    v_exp_f32 v202, v202
    v_mfma_f32_16x16x32_bf16 v[52:55], a[244:247], v[232:235], v[52:55]
    v_add_f32 v216, v216, v201
    v_cvt_pk_bf16_f32 v244, v200, v201
    v_mfma_f32_16x16x32_bf16 v[52:55], a[180:183], v[212:215], v[52:55]
    v_exp_f32 v203, v203
    v_mfma_f32_16x16x32_bf16 v[48:51], a[240:243], v[232:235], v[48:51]
    ds_read_b64_tr_b16 a[192:193], v229 offset:16896
    v_add_f32 v216, v216, v202
    v_mfma_f32_16x16x32_bf16 v[48:51], a[176:179], v[212:215], v[48:51]
    v_exp_f32 v204, v204
    v_mfma_f32_16x16x32_bf16 v[192:195], a[128:131], a[48:51], 0
    v_add_f32 v216, v216, v203
    v_cvt_pk_bf16_f32 v245, v202, v203
    v_mfma_f32_16x16x32_bf16 v[192:195], a[132:135], a[52:55], v[192:195]
    v_exp_f32 v205, v205
    v_mfma_f32_16x16x32_bf16 v[192:195], a[136:139], a[56:59], v[192:195]
    ds_read_b64_tr_b16 a[194:195], v229 offset:25344
    v_add_f32 v216, v216, v204
    v_mfma_f32_16x16x32_bf16 v[192:195], a[140:143], a[60:63], v[192:195]
    v_exp_f32 v206, v206
    v_mfma_f32_16x16x32_bf16 v[196:199], a[156:159], a[60:63], 0
    v_add_f32 v216, v216, v205
    v_cvt_pk_bf16_f32 v246, v204, v205
    v_mfma_f32_16x16x32_bf16 v[196:199], a[152:155], a[56:59], v[196:199]
    v_exp_f32 v207, v207
    v_mfma_f32_16x16x32_bf16 v[196:199], a[148:151], a[52:55], v[196:199]
    ds_read_b64_tr_b16 a[196:197], v229 offset:16928
    v_add_f32 v216, v216, v206
    v_mfma_f32_16x16x32_bf16 v[196:199], a[144:147], a[48:51], v[196:199]
    v_add_f32 v216, v216, v207
    v_cvt_pk_bf16_f32 v247, v206, v207
    v_mfma_f32_16x16x32_bf16 v[204:207], a[144:147], a[32:35], 0
    v_exp_f32 v192, v192
    v_mfma_f32_16x16x32_bf16 v[204:207], a[148:151], a[36:39], v[204:207]
    v_exp_f32 v193, v193
    v_mfma_f32_16x16x32_bf16 v[204:207], a[152:155], a[40:43], v[204:207]
    ds_read_b128 a[116:119], v228 offset:25600
    v_add_f32 v219, v219, v192
    v_mfma_f32_16x16x32_bf16 v[204:207], a[156:159], a[44:47], v[204:207]
    buffer_load_dwordx4 v224, s[12:15], s22 offen offset:2112 nt lds
    v_exp_f32 v194, v194
    v_mfma_f32_16x16x32_bf16 v[200:203], a[140:143], a[44:47], 0
    v_add_f32 v219, v219, v193
    v_cvt_pk_bf16_f32 v208, v192, v193
    v_mfma_f32_16x16x32_bf16 v[200:203], a[136:139], a[40:43], v[200:203]
    v_exp_f32 v195, v195
    v_mfma_f32_16x16x32_bf16 v[200:203], a[132:135], a[36:39], v[200:203]
    ds_read_b64_tr_b16 a[198:199], v229 offset:25376
    v_add_f32 v219, v219, v194
    v_mfma_f32_16x16x32_bf16 v[200:203], a[128:131], a[32:35], v[200:203]
    v_exp_f32 v196, v196
    v_mfma_f32_16x16x32_bf16 v[44:47], a[236:239], v[232:235], v[44:47]
    v_add_f32 v219, v219, v195
    v_cvt_pk_bf16_f32 v209, v194, v195
    v_mfma_f32_16x16x32_bf16 v[44:47], a[172:175], v[212:215], v[44:47]
    v_exp_f32 v197, v197
    v_mfma_f32_16x16x32_bf16 v[40:43], a[232:235], v[232:235], v[40:43]
    ds_read_b64_tr_b16 a[200:201], v229 offset:17152
    v_add_f32 v219, v219, v196
    v_mfma_f32_16x16x32_bf16 v[40:43], a[168:171], v[212:215], v[40:43]
    v_exp_f32 v198, v198
    v_mfma_f32_16x16x32_bf16 v[36:39], a[228:231], v[232:235], v[36:39]
    v_add_f32 v219, v219, v197
    v_cvt_pk_bf16_f32 v210, v196, v197
    v_mfma_f32_16x16x32_bf16 v[36:39], a[164:167], v[212:215], v[36:39]
    v_exp_f32 v199, v199
    v_mfma_f32_16x16x32_bf16 v[32:35], a[224:227], v[232:235], v[32:35]
    v_cvt_pk_bf16_f32 v211, v198, v199
    v_add_f32 v219, v219, v198
    v_mfma_f32_16x16x32_bf16 v[32:35], a[160:163], v[212:215], v[32:35]
    ds_read_b64_tr_b16 a[202:203], v229 offset:25600
    v_add_f32 v219, v219, v199
    v_mfma_f32_16x16x32_bf16 v[96:99], a[160:163], v[208:211], v[96:99]
    v_exp_f32 v200, v200
    v_mfma_f32_16x16x32_bf16 v[96:99], a[224:227], v[236:239], v[96:99]
    v_exp_f32 v201, v201
    v_mfma_f32_16x16x32_bf16 v[100:103], a[228:231], v[236:239], v[100:103]
    ds_read_b128 a[120:123], v228 offset:25856
    v_add_f32 v218, v218, v200
    v_mfma_f32_16x16x32_bf16 v[100:103], a[164:167], v[208:211], v[100:103]
    buffer_load_dwordx4 v225, s[12:15], s22 offen offset:3168 nt lds
    v_exp_f32 v202, v202
    v_mfma_f32_16x16x32_bf16 v[104:107], a[232:235], v[236:239], v[104:107]
    v_add_f32 v218, v218, v201
    v_cvt_pk_bf16_f32 v248, v200, v201
    v_mfma_f32_16x16x32_bf16 v[104:107], a[168:171], v[208:211], v[104:107]
    s_add_u32 s22, s22, 8192
    v_exp_f32 v203, v203
    v_mfma_f32_16x16x32_bf16 v[108:111], a[236:239], v[236:239], v[108:111]
    ds_read_b64_tr_b16 a[204:205], v229 offset:17184
    v_add_f32 v218, v218, v202
    v_mfma_f32_16x16x32_bf16 v[108:111], a[172:175], v[208:211], v[108:111]
    v_exp_f32 v204, v204
    v_mfma_f32_16x16x32_bf16 v[192:195], a[128:131], a[80:83], 0
    v_add_f32 v218, v218, v203
    v_cvt_pk_bf16_f32 v249, v202, v203
    v_mfma_f32_16x16x32_bf16 v[192:195], a[132:135], a[84:87], v[192:195]
    v_exp_f32 v205, v205
    v_mfma_f32_16x16x32_bf16 v[192:195], a[136:139], a[88:91], v[192:195]
    ds_read_b64_tr_b16 a[206:207], v229 offset:25632
    v_add_f32 v218, v218, v204
    v_mfma_f32_16x16x32_bf16 v[192:195], a[140:143], a[92:95], v[192:195]
    v_exp_f32 v206, v206
    v_mfma_f32_16x16x32_bf16 v[196:199], a[156:159], a[92:95], 0
    v_add_f32 v218, v218, v205
    v_cvt_pk_bf16_f32 v250, v204, v205
    v_mfma_f32_16x16x32_bf16 v[196:199], a[152:155], a[88:91], v[196:199]
    v_exp_f32 v207, v207
    v_mfma_f32_16x16x32_bf16 v[196:199], a[148:151], a[84:87], v[196:199]
    ds_read_b64_tr_b16 a[208:209], v229 offset:17408
    v_add_f32 v218, v218, v206
    v_mfma_f32_16x16x32_bf16 v[196:199], a[144:147], a[80:83], v[196:199]
    v_add_f32 v218, v218, v207
    v_cvt_pk_bf16_f32 v251, v206, v207
    v_mfma_f32_16x16x32_bf16 v[204:207], a[144:147], a[64:67], 0
    v_exp_f32 v192, v192
    v_mfma_f32_16x16x32_bf16 v[204:207], a[148:151], a[68:71], v[204:207]
    v_exp_f32 v193, v193
    v_mfma_f32_16x16x32_bf16 v[204:207], a[152:155], a[72:75], v[204:207]
    ds_read_b128 a[124:127], v228 offset:26112
    v_add_f32 v221, v221, v192
    v_mfma_f32_16x16x32_bf16 v[204:207], a[156:159], a[76:79], v[204:207]
    v_exp_f32 v194, v194
    v_mfma_f32_16x16x32_bf16 v[200:203], a[140:143], a[76:79], 0
    v_add_f32 v221, v221, v193
    v_cvt_pk_bf16_f32 v212, v192, v193
    v_mfma_f32_16x16x32_bf16 v[200:203], a[136:139], a[72:75], v[200:203]
    v_exp_f32 v195, v195
    v_mfma_f32_16x16x32_bf16 v[200:203], a[132:135], a[68:71], v[200:203]
    ds_read_b64_tr_b16 a[210:211], v229 offset:25856
    v_add_f32 v221, v221, v194
    v_mfma_f32_16x16x32_bf16 v[200:203], a[128:131], a[64:67], v[200:203]
    v_exp_f32 v196, v196
    v_mfma_f32_16x16x32_bf16 v[112:115], a[240:243], v[236:239], v[112:115]
    v_add_f32 v221, v221, v195
    v_cvt_pk_bf16_f32 v213, v194, v195
    v_mfma_f32_16x16x32_bf16 v[112:115], a[176:179], v[208:211], v[112:115]
    v_exp_f32 v197, v197
    v_mfma_f32_16x16x32_bf16 v[116:119], a[244:247], v[236:239], v[116:119]
    ds_read_b64_tr_b16 a[212:213], v229 offset:17440
    v_add_f32 v221, v221, v196
    v_mfma_f32_16x16x32_bf16 v[116:119], a[180:183], v[208:211], v[116:119]
    v_exp_f32 v198, v198
    v_mfma_f32_16x16x32_bf16 v[120:123], a[248:251], v[236:239], v[120:123]
    v_add_f32 v221, v221, v197
    v_cvt_pk_bf16_f32 v214, v196, v197
    v_mfma_f32_16x16x32_bf16 v[120:123], a[184:187], v[208:211], v[120:123]
    v_exp_f32 v199, v199
    v_mfma_f32_16x16x32_bf16 v[124:127], a[252:255], v[236:239], v[124:127]
    v_cvt_pk_bf16_f32 v215, v198, v199
    v_add_f32 v221, v221, v198
    v_mfma_f32_16x16x32_bf16 v[124:127], a[188:191], v[208:211], v[124:127]
    ds_read_b64_tr_b16 a[214:215], v229 offset:25888
    v_add_f32 v221, v221, v199
    v_mfma_f32_16x16x32_bf16 v[188:191], a[188:191], v[212:215], v[188:191]
    v_exp_f32 v200, v200
    v_mfma_f32_16x16x32_bf16 v[188:191], a[252:255], v[240:243], v[188:191]
    v_exp_f32 v201, v201
    v_mfma_f32_16x16x32_bf16 v[184:187], a[248:251], v[240:243], v[184:187]
    ds_read_b64_tr_b16 a[216:217], v229 offset:17664
    v_add_f32 v220, v220, v200
    v_mfma_f32_16x16x32_bf16 v[184:187], a[184:187], v[212:215], v[184:187]
    v_exp_f32 v202, v202
    v_mfma_f32_16x16x32_bf16 v[180:183], a[244:247], v[240:243], v[180:183]
    s_waitcnt lgkmcnt(4)
    v_add_f32 v220, v220, v201
    v_cvt_pk_bf16_f32 v252, v200, v201
    v_mfma_f32_16x16x32_bf16 v[180:183], a[180:183], v[212:215], v[180:183]
    v_exp_f32 v203, v203
    v_mfma_f32_16x16x32_bf16 v[176:179], a[240:243], v[240:243], v[176:179]
    ds_read_b64_tr_b16 a[218:219], v229 offset:26112
    v_add_f32 v220, v220, v202
    v_mfma_f32_16x16x32_bf16 v[176:179], a[176:179], v[212:215], v[176:179]
    v_exp_f32 v204, v204
    v_mfma_f32_16x16x32_bf16 v[192:195], a[96:99], a[0:3], 0
    v_add_f32 v220, v220, v203
    v_cvt_pk_bf16_f32 v253, v202, v203
    v_mfma_f32_16x16x32_bf16 v[192:195], a[100:103], a[4:7], v[192:195]
    v_exp_f32 v205, v205
    v_mfma_f32_16x16x32_bf16 v[192:195], a[104:107], a[8:11], v[192:195]
    ds_read_b64_tr_b16 a[220:221], v229 offset:17696
    v_add_f32 v220, v220, v204
    v_mfma_f32_16x16x32_bf16 v[192:195], a[108:111], a[12:15], v[192:195]
    v_exp_f32 v206, v206
    v_mfma_f32_16x16x32_bf16 v[196:199], a[124:127], a[12:15], 0
    v_add_f32 v220, v220, v205
    v_cvt_pk_bf16_f32 v254, v204, v205
    v_mfma_f32_16x16x32_bf16 v[196:199], a[120:123], a[8:11], v[196:199]
    v_exp_f32 v207, v207
    v_mfma_f32_16x16x32_bf16 v[196:199], a[116:119], a[4:7], v[196:199]
    ds_read_b64_tr_b16 a[222:223], v229 offset:26144
    v_add_f32 v220, v220, v206
    v_mfma_f32_16x16x32_bf16 v[196:199], a[112:115], a[0:3], v[196:199]
    v_add_f32 v220, v220, v207
    v_cvt_pk_bf16_f32 v255, v206, v207
    v_mfma_f32_16x16x32_bf16 v[204:207], a[112:115], a[16:19], 0
    s_waitcnt vmcnt(4)
    s_barrier
    v_exp_f32 v192, v192
    v_mfma_f32_16x16x32_bf16 v[204:207], a[116:119], a[20:23], v[204:207]
    s_add_u32 m0, s21, 16896
    v_exp_f32 v193, v193
    v_mfma_f32_16x16x32_bf16 v[204:207], a[120:123], a[24:27], v[204:207]
    ds_read_b128 a[128:131], v228 offset:33792
    v_add_f32 v216, v216, v192
    v_mfma_f32_16x16x32_bf16 v[204:207], a[124:127], a[28:31], v[204:207]
    buffer_load_dwordx4 v224, s[8:11], s22 offen nt lds
    v_exp_f32 v194, v194
    v_mfma_f32_16x16x32_bf16 v[200:203], a[108:111], a[28:31], 0
    v_add_f32 v216, v216, v193
    v_cvt_pk_bf16_f32 v208, v192, v193
    v_mfma_f32_16x16x32_bf16 v[200:203], a[104:107], a[24:27], v[200:203]
    v_exp_f32 v195, v195
    v_mfma_f32_16x16x32_bf16 v[200:203], a[100:103], a[20:23], v[200:203]
    ds_read_b128 a[132:135], v228 offset:34048
    v_add_f32 v216, v216, v194
    v_mfma_f32_16x16x32_bf16 v[200:203], a[96:99], a[16:19], v[200:203]
    v_exp_f32 v196, v196
    v_mfma_f32_16x16x32_bf16 v[172:175], a[236:239], v[240:243], v[172:175]
    v_add_f32 v216, v216, v195
    v_cvt_pk_bf16_f32 v209, v194, v195
    v_mfma_f32_16x16x32_bf16 v[172:175], a[172:175], v[212:215], v[172:175]
    v_exp_f32 v197, v197
    v_mfma_f32_16x16x32_bf16 v[168:171], a[232:235], v[240:243], v[168:171]
    ds_read_b128 a[136:139], v228 offset:34304
    v_add_f32 v216, v216, v196
    v_mfma_f32_16x16x32_bf16 v[168:171], a[168:171], v[212:215], v[168:171]
    v_exp_f32 v198, v198
    v_mfma_f32_16x16x32_bf16 v[164:167], a[228:231], v[240:243], v[164:167]
    v_add_f32 v216, v216, v197
    v_cvt_pk_bf16_f32 v210, v196, v197
    v_mfma_f32_16x16x32_bf16 v[164:167], a[164:167], v[212:215], v[164:167]
    v_exp_f32 v199, v199
    v_mfma_f32_16x16x32_bf16 v[160:163], a[224:227], v[240:243], v[160:163]
    v_cvt_pk_bf16_f32 v211, v198, v199
    v_add_f32 v216, v216, v198
    v_mfma_f32_16x16x32_bf16 v[160:163], a[160:163], v[212:215], v[160:163]
    s_waitcnt lgkmcnt(3)
    ds_read_b128 a[140:143], v228 offset:34560
    v_add_f32 v216, v216, v199
    v_mfma_f32_16x16x32_bf16 v[0:3], a[160:163], v[244:247], v[0:3]
    v_exp_f32 v200, v200
    v_mfma_f32_16x16x32_bf16 v[0:3], a[192:195], v[208:211], v[0:3]
    v_exp_f32 v201, v201
    v_mfma_f32_16x16x32_bf16 v[4:7], a[164:167], v[244:247], v[4:7]
    ds_read_b128 a[144:147], v228 offset:42240
    v_add_f32 v217, v217, v200
    v_mfma_f32_16x16x32_bf16 v[4:7], a[196:199], v[208:211], v[4:7]
    buffer_load_dwordx4 v225, s[8:11], s22 offen offset:1056 nt lds
    v_exp_f32 v202, v202
    v_mfma_f32_16x16x32_bf16 v[8:11], a[168:171], v[244:247], v[8:11]
    v_add_f32 v217, v217, v201
    v_cvt_pk_bf16_f32 v232, v200, v201
    v_mfma_f32_16x16x32_bf16 v[8:11], a[200:203], v[208:211], v[8:11]
    v_exp_f32 v203, v203
    v_mfma_f32_16x16x32_bf16 v[12:15], a[172:175], v[244:247], v[12:15]
    ds_read_b64_tr_b16 a[224:225], v229 offset:33792
    v_add_f32 v217, v217, v202
    v_mfma_f32_16x16x32_bf16 v[12:15], a[204:207], v[208:211], v[12:15]
    v_exp_f32 v204, v204
    v_mfma_f32_16x16x32_bf16 v[192:195], a[96:99], a[32:35], 0
    v_add_f32 v217, v217, v203
    v_cvt_pk_bf16_f32 v233, v202, v203
    v_mfma_f32_16x16x32_bf16 v[192:195], a[100:103], a[36:39], v[192:195]
    v_exp_f32 v205, v205
    v_mfma_f32_16x16x32_bf16 v[192:195], a[104:107], a[40:43], v[192:195]
    ds_read_b64_tr_b16 a[226:227], v229 offset:42240
    v_add_f32 v217, v217, v204
    v_mfma_f32_16x16x32_bf16 v[192:195], a[108:111], a[44:47], v[192:195]
    v_exp_f32 v206, v206
    v_mfma_f32_16x16x32_bf16 v[196:199], a[124:127], a[44:47], 0
    v_add_f32 v217, v217, v205
    v_cvt_pk_bf16_f32 v234, v204, v205
    v_mfma_f32_16x16x32_bf16 v[196:199], a[120:123], a[40:43], v[196:199]
    v_exp_f32 v207, v207
    v_mfma_f32_16x16x32_bf16 v[196:199], a[116:119], a[36:39], v[196:199]
    ds_read_b64_tr_b16 a[228:229], v229 offset:33824
    v_add_f32 v217, v217, v206
    v_mfma_f32_16x16x32_bf16 v[196:199], a[112:115], a[32:35], v[196:199]
    v_add_f32 v217, v217, v207
    v_cvt_pk_bf16_f32 v235, v206, v207
    v_mfma_f32_16x16x32_bf16 v[204:207], a[112:115], a[48:51], 0
    v_exp_f32 v192, v192
    v_mfma_f32_16x16x32_bf16 v[204:207], a[116:119], a[52:55], v[204:207]
    v_exp_f32 v193, v193
    v_mfma_f32_16x16x32_bf16 v[204:207], a[120:123], a[56:59], v[204:207]
    ds_read_b128 a[148:151], v228 offset:42496
    v_add_f32 v218, v218, v192
    v_mfma_f32_16x16x32_bf16 v[204:207], a[124:127], a[60:63], v[204:207]
    buffer_load_dwordx4 v224, s[12:15], s22 offen offset:2112 nt lds
    v_exp_f32 v194, v194
    v_mfma_f32_16x16x32_bf16 v[200:203], a[108:111], a[60:63], 0
    v_add_f32 v218, v218, v193
    v_cvt_pk_bf16_f32 v212, v192, v193
    v_mfma_f32_16x16x32_bf16 v[200:203], a[104:107], a[56:59], v[200:203]
    v_exp_f32 v195, v195
    v_mfma_f32_16x16x32_bf16 v[200:203], a[100:103], a[52:55], v[200:203]
    ds_read_b64_tr_b16 a[230:231], v229 offset:42272
    v_add_f32 v218, v218, v194
    v_mfma_f32_16x16x32_bf16 v[200:203], a[96:99], a[48:51], v[200:203]
    v_exp_f32 v196, v196
    v_mfma_f32_16x16x32_bf16 v[16:19], a[176:179], v[244:247], v[16:19]
    v_add_f32 v218, v218, v195
    v_cvt_pk_bf16_f32 v213, v194, v195
    v_mfma_f32_16x16x32_bf16 v[16:19], a[208:211], v[208:211], v[16:19]
    v_exp_f32 v197, v197
    v_mfma_f32_16x16x32_bf16 v[20:23], a[180:183], v[244:247], v[20:23]
    ds_read_b64_tr_b16 a[232:233], v229 offset:34048
    v_add_f32 v218, v218, v196
    v_mfma_f32_16x16x32_bf16 v[20:23], a[212:215], v[208:211], v[20:23]
    v_exp_f32 v198, v198
    v_mfma_f32_16x16x32_bf16 v[24:27], a[184:187], v[244:247], v[24:27]
    v_add_f32 v218, v218, v197
    v_cvt_pk_bf16_f32 v214, v196, v197
    v_mfma_f32_16x16x32_bf16 v[24:27], a[216:219], v[208:211], v[24:27]
    v_exp_f32 v199, v199
    v_mfma_f32_16x16x32_bf16 v[28:31], a[188:191], v[244:247], v[28:31]
    v_cvt_pk_bf16_f32 v215, v198, v199
    v_add_f32 v218, v218, v198
    v_mfma_f32_16x16x32_bf16 v[28:31], a[220:223], v[208:211], v[28:31]
    ds_read_b64_tr_b16 a[234:235], v229 offset:42496
    v_add_f32 v218, v218, v199
    v_mfma_f32_16x16x32_bf16 v[92:95], a[220:223], v[212:215], v[92:95]
    v_exp_f32 v200, v200
    v_mfma_f32_16x16x32_bf16 v[92:95], a[188:191], v[248:251], v[92:95]
    v_exp_f32 v201, v201
    v_mfma_f32_16x16x32_bf16 v[88:91], a[184:187], v[248:251], v[88:91]
    ds_read_b128 a[152:155], v228 offset:42752
    v_add_f32 v219, v219, v200
    v_mfma_f32_16x16x32_bf16 v[88:91], a[216:219], v[212:215], v[88:91]
    buffer_load_dwordx4 v225, s[12:15], s22 offen offset:3168 nt lds
    v_exp_f32 v202, v202
    v_mfma_f32_16x16x32_bf16 v[84:87], a[180:183], v[248:251], v[84:87]
    v_add_f32 v219, v219, v201
    v_cvt_pk_bf16_f32 v236, v200, v201
    v_mfma_f32_16x16x32_bf16 v[84:87], a[212:215], v[212:215], v[84:87]
    s_add_u32 s22, s22, 8192
    v_exp_f32 v203, v203
    v_mfma_f32_16x16x32_bf16 v[80:83], a[176:179], v[248:251], v[80:83]
    ds_read_b64_tr_b16 a[236:237], v229 offset:34080
    v_add_f32 v219, v219, v202
    v_mfma_f32_16x16x32_bf16 v[80:83], a[208:211], v[212:215], v[80:83]
    v_exp_f32 v204, v204
    v_mfma_f32_16x16x32_bf16 v[192:195], a[96:99], a[64:67], 0
    v_add_f32 v219, v219, v203
    v_cvt_pk_bf16_f32 v237, v202, v203
    v_mfma_f32_16x16x32_bf16 v[192:195], a[100:103], a[68:71], v[192:195]
    v_exp_f32 v205, v205
    v_mfma_f32_16x16x32_bf16 v[192:195], a[104:107], a[72:75], v[192:195]
    ds_read_b64_tr_b16 a[238:239], v229 offset:42528
    v_add_f32 v219, v219, v204
    v_mfma_f32_16x16x32_bf16 v[192:195], a[108:111], a[76:79], v[192:195]
    v_exp_f32 v206, v206
    v_mfma_f32_16x16x32_bf16 v[196:199], a[124:127], a[76:79], 0
    v_add_f32 v219, v219, v205
    v_cvt_pk_bf16_f32 v238, v204, v205
    v_mfma_f32_16x16x32_bf16 v[196:199], a[120:123], a[72:75], v[196:199]
    v_exp_f32 v207, v207
    v_mfma_f32_16x16x32_bf16 v[196:199], a[116:119], a[68:71], v[196:199]
    ds_read_b64_tr_b16 a[240:241], v229 offset:34304
    v_add_f32 v219, v219, v206
    v_mfma_f32_16x16x32_bf16 v[196:199], a[112:115], a[64:67], v[196:199]
    v_add_f32 v219, v219, v207
    v_cvt_pk_bf16_f32 v239, v206, v207
    v_mfma_f32_16x16x32_bf16 v[204:207], a[112:115], a[80:83], 0
    v_exp_f32 v192, v192
    v_mfma_f32_16x16x32_bf16 v[204:207], a[116:119], a[84:87], v[204:207]
    v_exp_f32 v193, v193
    v_mfma_f32_16x16x32_bf16 v[204:207], a[120:123], a[88:91], v[204:207]
    ds_read_b128 a[156:159], v228 offset:43008
    v_add_f32 v220, v220, v192
    v_mfma_f32_16x16x32_bf16 v[204:207], a[124:127], a[92:95], v[204:207]
    v_exp_f32 v194, v194
    v_mfma_f32_16x16x32_bf16 v[200:203], a[108:111], a[92:95], 0
    v_add_f32 v220, v220, v193
    v_cvt_pk_bf16_f32 v208, v192, v193
    v_mfma_f32_16x16x32_bf16 v[200:203], a[104:107], a[88:91], v[200:203]
    v_exp_f32 v195, v195
    v_mfma_f32_16x16x32_bf16 v[200:203], a[100:103], a[84:87], v[200:203]
    ds_read_b64_tr_b16 a[242:243], v229 offset:42752
    v_add_f32 v220, v220, v194
    v_mfma_f32_16x16x32_bf16 v[200:203], a[96:99], a[80:83], v[200:203]
    v_exp_f32 v196, v196
    v_mfma_f32_16x16x32_bf16 v[76:79], a[172:175], v[248:251], v[76:79]
    v_add_f32 v220, v220, v195
    v_cvt_pk_bf16_f32 v209, v194, v195
    v_mfma_f32_16x16x32_bf16 v[76:79], a[204:207], v[212:215], v[76:79]
    v_exp_f32 v197, v197
    v_mfma_f32_16x16x32_bf16 v[72:75], a[168:171], v[248:251], v[72:75]
    ds_read_b64_tr_b16 a[244:245], v229 offset:34336
    v_add_f32 v220, v220, v196
    v_mfma_f32_16x16x32_bf16 v[72:75], a[200:203], v[212:215], v[72:75]
    v_exp_f32 v198, v198
    v_mfma_f32_16x16x32_bf16 v[68:71], a[164:167], v[248:251], v[68:71]
    v_add_f32 v220, v220, v197
    v_cvt_pk_bf16_f32 v210, v196, v197
    v_mfma_f32_16x16x32_bf16 v[68:71], a[196:199], v[212:215], v[68:71]
    v_exp_f32 v199, v199
    v_mfma_f32_16x16x32_bf16 v[64:67], a[160:163], v[248:251], v[64:67]
    v_cvt_pk_bf16_f32 v211, v198, v199
    v_add_f32 v220, v220, v198
    v_mfma_f32_16x16x32_bf16 v[64:67], a[192:195], v[212:215], v[64:67]
    ds_read_b64_tr_b16 a[246:247], v229 offset:42784
    v_add_f32 v220, v220, v199
    v_mfma_f32_16x16x32_bf16 v[128:131], a[192:195], v[208:211], v[128:131]
    v_exp_f32 v200, v200
    v_mfma_f32_16x16x32_bf16 v[128:131], a[160:163], v[252:255], v[128:131]
    v_exp_f32 v201, v201
    v_mfma_f32_16x16x32_bf16 v[132:135], a[164:167], v[252:255], v[132:135]
    ds_read_b64_tr_b16 a[248:249], v229 offset:34560
    v_add_f32 v221, v221, v200
    v_mfma_f32_16x16x32_bf16 v[132:135], a[196:199], v[208:211], v[132:135]
    v_exp_f32 v202, v202
    v_mfma_f32_16x16x32_bf16 v[136:139], a[168:171], v[252:255], v[136:139]
    s_waitcnt lgkmcnt(4)
    v_add_f32 v221, v221, v201
    v_cvt_pk_bf16_f32 v240, v200, v201
    v_mfma_f32_16x16x32_bf16 v[136:139], a[200:203], v[208:211], v[136:139]
    v_exp_f32 v203, v203
    v_mfma_f32_16x16x32_bf16 v[140:143], a[172:175], v[252:255], v[140:143]
    ds_read_b64_tr_b16 a[250:251], v229 offset:43008
    v_add_f32 v221, v221, v202
    v_mfma_f32_16x16x32_bf16 v[140:143], a[204:207], v[208:211], v[140:143]
    v_exp_f32 v204, v204
    v_mfma_f32_16x16x32_bf16 v[192:195], a[128:131], a[16:19], 0
    v_add_f32 v221, v221, v203
    v_cvt_pk_bf16_f32 v241, v202, v203
    v_mfma_f32_16x16x32_bf16 v[192:195], a[132:135], a[20:23], v[192:195]
    v_exp_f32 v205, v205
    v_mfma_f32_16x16x32_bf16 v[192:195], a[136:139], a[24:27], v[192:195]
    ds_read_b64_tr_b16 a[252:253], v229 offset:34592
    v_add_f32 v221, v221, v204
    v_mfma_f32_16x16x32_bf16 v[192:195], a[140:143], a[28:31], v[192:195]
    v_exp_f32 v206, v206
    v_mfma_f32_16x16x32_bf16 v[196:199], a[156:159], a[28:31], 0
    v_add_f32 v221, v221, v205
    v_cvt_pk_bf16_f32 v242, v204, v205
    v_mfma_f32_16x16x32_bf16 v[196:199], a[152:155], a[24:27], v[196:199]
    v_exp_f32 v207, v207
    v_mfma_f32_16x16x32_bf16 v[196:199], a[148:151], a[20:23], v[196:199]
    ds_read_b64_tr_b16 a[254:255], v229 offset:43040
    v_add_f32 v221, v221, v206
    v_mfma_f32_16x16x32_bf16 v[196:199], a[144:147], a[16:19], v[196:199]
    v_add_f32 v221, v221, v207
    v_cvt_pk_bf16_f32 v243, v206, v207
    v_mfma_f32_16x16x32_bf16 v[204:207], a[144:147], a[0:3], 0
    s_waitcnt vmcnt(4)
    s_barrier
    v_exp_f32 v192, v192
    v_mfma_f32_16x16x32_bf16 v[204:207], a[148:151], a[4:7], v[204:207]
    s_add_u32 m0, s21, 33792
    v_exp_f32 v193, v193
    v_mfma_f32_16x16x32_bf16 v[204:207], a[152:155], a[8:11], v[204:207]
    ds_read_b128 a[96:99], v222 offset:0
    v_add_f32 v217, v217, v192
    v_mfma_f32_16x16x32_bf16 v[204:207], a[156:159], a[12:15], v[204:207]
    buffer_load_dwordx4 v224, s[8:11], s22 offen nt lds
    v_exp_f32 v194, v194
    v_mfma_f32_16x16x32_bf16 v[200:203], a[140:143], a[12:15], 0
    v_add_f32 v217, v217, v193
    v_cvt_pk_bf16_f32 v212, v192, v193
    v_mfma_f32_16x16x32_bf16 v[200:203], a[136:139], a[8:11], v[200:203]
    v_exp_f32 v195, v195
    v_mfma_f32_16x16x32_bf16 v[200:203], a[132:135], a[4:7], v[200:203]
    ds_read_b128 a[100:103], v222 offset:256
    v_add_f32 v217, v217, v194
    v_mfma_f32_16x16x32_bf16 v[200:203], a[128:131], a[0:3], v[200:203]
    v_exp_f32 v196, v196
    v_mfma_f32_16x16x32_bf16 v[144:147], a[176:179], v[252:255], v[144:147]
    v_add_f32 v217, v217, v195
    v_cvt_pk_bf16_f32 v213, v194, v195
    v_mfma_f32_16x16x32_bf16 v[144:147], a[208:211], v[208:211], v[144:147]
    v_exp_f32 v197, v197
    v_mfma_f32_16x16x32_bf16 v[148:151], a[180:183], v[252:255], v[148:151]
    ds_read_b128 a[104:107], v222 offset:512
    v_add_f32 v217, v217, v196
    v_mfma_f32_16x16x32_bf16 v[148:151], a[212:215], v[208:211], v[148:151]
    v_exp_f32 v198, v198
    v_mfma_f32_16x16x32_bf16 v[152:155], a[184:187], v[252:255], v[152:155]
    v_add_f32 v217, v217, v197
    v_cvt_pk_bf16_f32 v214, v196, v197
    v_mfma_f32_16x16x32_bf16 v[152:155], a[216:219], v[208:211], v[152:155]
    v_exp_f32 v199, v199
    v_mfma_f32_16x16x32_bf16 v[156:159], a[188:191], v[252:255], v[156:159]
    v_cvt_pk_bf16_f32 v215, v198, v199
    v_add_f32 v217, v217, v198
    v_mfma_f32_16x16x32_bf16 v[156:159], a[220:223], v[208:211], v[156:159]
    s_waitcnt lgkmcnt(3)
    ds_read_b128 a[108:111], v222 offset:768
    v_add_f32 v217, v217, v199
    v_mfma_f32_16x16x32_bf16 v[60:63], a[220:223], v[232:235], v[60:63]
    v_exp_f32 v200, v200
    v_mfma_f32_16x16x32_bf16 v[60:63], a[252:255], v[212:215], v[60:63]
    v_exp_f32 v201, v201
    v_mfma_f32_16x16x32_bf16 v[56:59], a[216:219], v[232:235], v[56:59]
    ds_read_b128 a[112:115], v222 offset:8448
    v_add_f32 v216, v216, v200
    v_mfma_f32_16x16x32_bf16 v[56:59], a[248:251], v[212:215], v[56:59]
    buffer_load_dwordx4 v225, s[8:11], s22 offen offset:1056 nt lds
    v_exp_f32 v202, v202
    v_mfma_f32_16x16x32_bf16 v[52:55], a[212:215], v[232:235], v[52:55]
    v_add_f32 v216, v216, v201
    v_cvt_pk_bf16_f32 v244, v200, v201
    v_mfma_f32_16x16x32_bf16 v[52:55], a[244:247], v[212:215], v[52:55]
    v_exp_f32 v203, v203
    v_mfma_f32_16x16x32_bf16 v[48:51], a[208:211], v[232:235], v[48:51]
    ds_read_b64_tr_b16 a[160:161], v223 offset:0
    v_add_f32 v216, v216, v202
    v_mfma_f32_16x16x32_bf16 v[48:51], a[240:243], v[212:215], v[48:51]
    v_exp_f32 v204, v204
    v_mfma_f32_16x16x32_bf16 v[192:195], a[128:131], a[48:51], 0
    v_add_f32 v216, v216, v203
    v_cvt_pk_bf16_f32 v245, v202, v203
    v_mfma_f32_16x16x32_bf16 v[192:195], a[132:135], a[52:55], v[192:195]
    v_exp_f32 v205, v205
    v_mfma_f32_16x16x32_bf16 v[192:195], a[136:139], a[56:59], v[192:195]
    ds_read_b64_tr_b16 a[162:163], v223 offset:8448
    v_add_f32 v216, v216, v204
    v_mfma_f32_16x16x32_bf16 v[192:195], a[140:143], a[60:63], v[192:195]
    v_exp_f32 v206, v206
    v_mfma_f32_16x16x32_bf16 v[196:199], a[156:159], a[60:63], 0
    v_add_f32 v216, v216, v205
    v_cvt_pk_bf16_f32 v246, v204, v205
    v_mfma_f32_16x16x32_bf16 v[196:199], a[152:155], a[56:59], v[196:199]
    v_exp_f32 v207, v207
    v_mfma_f32_16x16x32_bf16 v[196:199], a[148:151], a[52:55], v[196:199]
    ds_read_b64_tr_b16 a[164:165], v223 offset:32
    v_add_f32 v216, v216, v206
    v_mfma_f32_16x16x32_bf16 v[196:199], a[144:147], a[48:51], v[196:199]
    v_add_f32 v216, v216, v207
    v_cvt_pk_bf16_f32 v247, v206, v207
    v_mfma_f32_16x16x32_bf16 v[204:207], a[144:147], a[32:35], 0
    v_exp_f32 v192, v192
    v_mfma_f32_16x16x32_bf16 v[204:207], a[148:151], a[36:39], v[204:207]
    v_exp_f32 v193, v193
    v_mfma_f32_16x16x32_bf16 v[204:207], a[152:155], a[40:43], v[204:207]
    ds_read_b128 a[116:119], v222 offset:8704
    v_add_f32 v219, v219, v192
    v_mfma_f32_16x16x32_bf16 v[204:207], a[156:159], a[44:47], v[204:207]
    buffer_load_dwordx4 v224, s[12:15], s22 offen offset:2112 nt lds
    v_exp_f32 v194, v194
    v_mfma_f32_16x16x32_bf16 v[200:203], a[140:143], a[44:47], 0
    v_add_f32 v219, v219, v193
    v_cvt_pk_bf16_f32 v208, v192, v193
    v_mfma_f32_16x16x32_bf16 v[200:203], a[136:139], a[40:43], v[200:203]
    v_exp_f32 v195, v195
    v_mfma_f32_16x16x32_bf16 v[200:203], a[132:135], a[36:39], v[200:203]
    ds_read_b64_tr_b16 a[166:167], v223 offset:8480
    v_add_f32 v219, v219, v194
    v_mfma_f32_16x16x32_bf16 v[200:203], a[128:131], a[32:35], v[200:203]
    v_exp_f32 v196, v196
    v_mfma_f32_16x16x32_bf16 v[44:47], a[204:207], v[232:235], v[44:47]
    v_add_f32 v219, v219, v195
    v_cvt_pk_bf16_f32 v209, v194, v195
    v_mfma_f32_16x16x32_bf16 v[44:47], a[236:239], v[212:215], v[44:47]
    v_exp_f32 v197, v197
    v_mfma_f32_16x16x32_bf16 v[40:43], a[200:203], v[232:235], v[40:43]
    ds_read_b64_tr_b16 a[168:169], v223 offset:256
    v_add_f32 v219, v219, v196
    v_mfma_f32_16x16x32_bf16 v[40:43], a[232:235], v[212:215], v[40:43]
    v_exp_f32 v198, v198
    v_mfma_f32_16x16x32_bf16 v[36:39], a[196:199], v[232:235], v[36:39]
    v_add_f32 v219, v219, v197
    v_cvt_pk_bf16_f32 v210, v196, v197
    v_mfma_f32_16x16x32_bf16 v[36:39], a[228:231], v[212:215], v[36:39]
    v_exp_f32 v199, v199
    v_mfma_f32_16x16x32_bf16 v[32:35], a[192:195], v[232:235], v[32:35]
    v_cvt_pk_bf16_f32 v211, v198, v199
    v_add_f32 v219, v219, v198
    v_mfma_f32_16x16x32_bf16 v[32:35], a[224:227], v[212:215], v[32:35]
    ds_read_b64_tr_b16 a[170:171], v223 offset:8704
    v_add_f32 v219, v219, v199
    v_mfma_f32_16x16x32_bf16 v[96:99], a[224:227], v[208:211], v[96:99]
    v_exp_f32 v200, v200
    v_mfma_f32_16x16x32_bf16 v[96:99], a[192:195], v[236:239], v[96:99]
    v_exp_f32 v201, v201
    v_mfma_f32_16x16x32_bf16 v[100:103], a[196:199], v[236:239], v[100:103]
    ds_read_b128 a[120:123], v222 offset:8960
    v_add_f32 v218, v218, v200
    v_mfma_f32_16x16x32_bf16 v[100:103], a[228:231], v[208:211], v[100:103]
    buffer_load_dwordx4 v225, s[12:15], s22 offen offset:3168 nt lds
    v_exp_f32 v202, v202
    v_mfma_f32_16x16x32_bf16 v[104:107], a[200:203], v[236:239], v[104:107]
    v_add_f32 v218, v218, v201
    v_cvt_pk_bf16_f32 v248, v200, v201
    v_mfma_f32_16x16x32_bf16 v[104:107], a[232:235], v[208:211], v[104:107]
    s_add_u32 s22, s22, 8192
    v_exp_f32 v203, v203
    v_mfma_f32_16x16x32_bf16 v[108:111], a[204:207], v[236:239], v[108:111]
    ds_read_b64_tr_b16 a[172:173], v223 offset:288
    v_add_f32 v218, v218, v202
    v_mfma_f32_16x16x32_bf16 v[108:111], a[236:239], v[208:211], v[108:111]
    v_exp_f32 v204, v204
    v_mfma_f32_16x16x32_bf16 v[192:195], a[128:131], a[80:83], 0
    v_add_f32 v218, v218, v203
    v_cvt_pk_bf16_f32 v249, v202, v203
    v_mfma_f32_16x16x32_bf16 v[192:195], a[132:135], a[84:87], v[192:195]
    v_exp_f32 v205, v205
    v_mfma_f32_16x16x32_bf16 v[192:195], a[136:139], a[88:91], v[192:195]
    ds_read_b64_tr_b16 a[174:175], v223 offset:8736
    v_add_f32 v218, v218, v204
    v_mfma_f32_16x16x32_bf16 v[192:195], a[140:143], a[92:95], v[192:195]
    v_exp_f32 v206, v206
    v_mfma_f32_16x16x32_bf16 v[196:199], a[156:159], a[92:95], 0
    v_add_f32 v218, v218, v205
    v_cvt_pk_bf16_f32 v250, v204, v205
    v_mfma_f32_16x16x32_bf16 v[196:199], a[152:155], a[88:91], v[196:199]
    v_exp_f32 v207, v207
    v_mfma_f32_16x16x32_bf16 v[196:199], a[148:151], a[84:87], v[196:199]
    ds_read_b64_tr_b16 a[176:177], v223 offset:512
    v_add_f32 v218, v218, v206
    v_mfma_f32_16x16x32_bf16 v[196:199], a[144:147], a[80:83], v[196:199]
    v_add_f32 v218, v218, v207
    v_cvt_pk_bf16_f32 v251, v206, v207
    v_mfma_f32_16x16x32_bf16 v[204:207], a[144:147], a[64:67], 0
    v_exp_f32 v192, v192
    v_mfma_f32_16x16x32_bf16 v[204:207], a[148:151], a[68:71], v[204:207]
    v_exp_f32 v193, v193
    v_mfma_f32_16x16x32_bf16 v[204:207], a[152:155], a[72:75], v[204:207]
    ds_read_b128 a[124:127], v222 offset:9216
    v_add_f32 v221, v221, v192
    v_mfma_f32_16x16x32_bf16 v[204:207], a[156:159], a[76:79], v[204:207]
    v_exp_f32 v194, v194
    v_mfma_f32_16x16x32_bf16 v[200:203], a[140:143], a[76:79], 0
    v_add_f32 v221, v221, v193
    v_cvt_pk_bf16_f32 v212, v192, v193
    v_mfma_f32_16x16x32_bf16 v[200:203], a[136:139], a[72:75], v[200:203]
    v_exp_f32 v195, v195
    v_mfma_f32_16x16x32_bf16 v[200:203], a[132:135], a[68:71], v[200:203]
    ds_read_b64_tr_b16 a[178:179], v223 offset:8960
    v_add_f32 v221, v221, v194
    v_mfma_f32_16x16x32_bf16 v[200:203], a[128:131], a[64:67], v[200:203]
    v_exp_f32 v196, v196
    v_mfma_f32_16x16x32_bf16 v[112:115], a[208:211], v[236:239], v[112:115]
    v_add_f32 v221, v221, v195
    v_cvt_pk_bf16_f32 v213, v194, v195
    v_mfma_f32_16x16x32_bf16 v[112:115], a[240:243], v[208:211], v[112:115]
    v_exp_f32 v197, v197
    v_mfma_f32_16x16x32_bf16 v[116:119], a[212:215], v[236:239], v[116:119]
    ds_read_b64_tr_b16 a[180:181], v223 offset:544
    v_add_f32 v221, v221, v196
    v_mfma_f32_16x16x32_bf16 v[116:119], a[244:247], v[208:211], v[116:119]
    v_exp_f32 v198, v198
    v_mfma_f32_16x16x32_bf16 v[120:123], a[216:219], v[236:239], v[120:123]
    v_add_f32 v221, v221, v197
    v_cvt_pk_bf16_f32 v214, v196, v197
    v_mfma_f32_16x16x32_bf16 v[120:123], a[248:251], v[208:211], v[120:123]
    v_exp_f32 v199, v199
    v_mfma_f32_16x16x32_bf16 v[124:127], a[220:223], v[236:239], v[124:127]
    v_cvt_pk_bf16_f32 v215, v198, v199
    v_add_f32 v221, v221, v198
    v_mfma_f32_16x16x32_bf16 v[124:127], a[252:255], v[208:211], v[124:127]
    ds_read_b64_tr_b16 a[182:183], v223 offset:8992
    v_add_f32 v221, v221, v199
    v_mfma_f32_16x16x32_bf16 v[188:191], a[252:255], v[212:215], v[188:191]
    v_exp_f32 v200, v200
    v_mfma_f32_16x16x32_bf16 v[188:191], a[220:223], v[240:243], v[188:191]
    v_exp_f32 v201, v201
    v_mfma_f32_16x16x32_bf16 v[184:187], a[216:219], v[240:243], v[184:187]
    ds_read_b64_tr_b16 a[184:185], v223 offset:768
    v_add_f32 v220, v220, v200
    v_mfma_f32_16x16x32_bf16 v[184:187], a[248:251], v[212:215], v[184:187]
    v_exp_f32 v202, v202
    v_mfma_f32_16x16x32_bf16 v[180:183], a[212:215], v[240:243], v[180:183]
    s_waitcnt lgkmcnt(4)
    v_add_f32 v220, v220, v201
    v_cvt_pk_bf16_f32 v252, v200, v201
    v_mfma_f32_16x16x32_bf16 v[180:183], a[244:247], v[212:215], v[180:183]
    v_exp_f32 v203, v203
    v_mfma_f32_16x16x32_bf16 v[176:179], a[208:211], v[240:243], v[176:179]
    ds_read_b64_tr_b16 a[186:187], v223 offset:9216
    v_add_f32 v220, v220, v202
    v_mfma_f32_16x16x32_bf16 v[176:179], a[240:243], v[212:215], v[176:179]
    v_exp_f32 v204, v204
    v_mfma_f32_16x16x32_bf16 v[192:195], a[96:99], a[0:3], 0
    v_add_f32 v220, v220, v203
    v_cvt_pk_bf16_f32 v253, v202, v203
    v_mfma_f32_16x16x32_bf16 v[192:195], a[100:103], a[4:7], v[192:195]
    v_exp_f32 v205, v205
    v_mfma_f32_16x16x32_bf16 v[192:195], a[104:107], a[8:11], v[192:195]
    ds_read_b64_tr_b16 a[188:189], v223 offset:800
    v_add_f32 v220, v220, v204
    v_mfma_f32_16x16x32_bf16 v[192:195], a[108:111], a[12:15], v[192:195]
    v_exp_f32 v206, v206
    v_mfma_f32_16x16x32_bf16 v[196:199], a[124:127], a[12:15], 0
    v_add_f32 v220, v220, v205
    v_cvt_pk_bf16_f32 v254, v204, v205
    v_mfma_f32_16x16x32_bf16 v[196:199], a[120:123], a[8:11], v[196:199]
    v_exp_f32 v207, v207
    v_mfma_f32_16x16x32_bf16 v[196:199], a[116:119], a[4:7], v[196:199]
    ds_read_b64_tr_b16 a[190:191], v223 offset:9248
    v_add_f32 v220, v220, v206
    v_mfma_f32_16x16x32_bf16 v[196:199], a[112:115], a[0:3], v[196:199]
    v_add_f32 v220, v220, v207
    v_cvt_pk_bf16_f32 v255, v206, v207
    v_mfma_f32_16x16x32_bf16 v[204:207], a[112:115], a[16:19], 0
    s_waitcnt vmcnt(4)
    s_barrier
    v_exp_f32 v192, v192
    v_mfma_f32_16x16x32_bf16 v[204:207], a[116:119], a[20:23], v[204:207]
    s_add_u32 m0, s21, 50688
    v_exp_f32 v193, v193
    v_mfma_f32_16x16x32_bf16 v[204:207], a[120:123], a[24:27], v[204:207]
    ds_read_b128 a[128:131], v222 offset:16896
    v_add_f32 v216, v216, v192
    v_mfma_f32_16x16x32_bf16 v[204:207], a[124:127], a[28:31], v[204:207]
    buffer_load_dwordx4 v224, s[8:11], s22 offen nt lds
    v_exp_f32 v194, v194
    v_mfma_f32_16x16x32_bf16 v[200:203], a[108:111], a[28:31], 0
    v_add_f32 v216, v216, v193
    v_cvt_pk_bf16_f32 v208, v192, v193
    v_mfma_f32_16x16x32_bf16 v[200:203], a[104:107], a[24:27], v[200:203]
    v_exp_f32 v195, v195
    v_mfma_f32_16x16x32_bf16 v[200:203], a[100:103], a[20:23], v[200:203]
    ds_read_b128 a[132:135], v222 offset:17152
    v_add_f32 v216, v216, v194
    v_mfma_f32_16x16x32_bf16 v[200:203], a[96:99], a[16:19], v[200:203]
    v_exp_f32 v196, v196
    v_mfma_f32_16x16x32_bf16 v[172:175], a[204:207], v[240:243], v[172:175]
    v_add_f32 v216, v216, v195
    v_cvt_pk_bf16_f32 v209, v194, v195
    v_mfma_f32_16x16x32_bf16 v[172:175], a[236:239], v[212:215], v[172:175]
    v_exp_f32 v197, v197
    v_mfma_f32_16x16x32_bf16 v[168:171], a[200:203], v[240:243], v[168:171]
    ds_read_b128 a[136:139], v222 offset:17408
    v_add_f32 v216, v216, v196
    v_mfma_f32_16x16x32_bf16 v[168:171], a[232:235], v[212:215], v[168:171]
    v_exp_f32 v198, v198
    v_mfma_f32_16x16x32_bf16 v[164:167], a[196:199], v[240:243], v[164:167]
    v_add_f32 v216, v216, v197
    v_cvt_pk_bf16_f32 v210, v196, v197
    v_mfma_f32_16x16x32_bf16 v[164:167], a[228:231], v[212:215], v[164:167]
    v_exp_f32 v199, v199
    v_mfma_f32_16x16x32_bf16 v[160:163], a[192:195], v[240:243], v[160:163]
    v_cvt_pk_bf16_f32 v211, v198, v199
    v_add_f32 v216, v216, v198
    v_mfma_f32_16x16x32_bf16 v[160:163], a[224:227], v[212:215], v[160:163]
    s_waitcnt lgkmcnt(3)
    ds_read_b128 a[140:143], v222 offset:17664
    v_add_f32 v216, v216, v199
    v_mfma_f32_16x16x32_bf16 v[0:3], a[224:227], v[244:247], v[0:3]
    v_exp_f32 v200, v200
    v_mfma_f32_16x16x32_bf16 v[0:3], a[160:163], v[208:211], v[0:3]
    v_exp_f32 v201, v201
    v_mfma_f32_16x16x32_bf16 v[4:7], a[228:231], v[244:247], v[4:7]
    ds_read_b128 a[144:147], v222 offset:25344
    v_add_f32 v217, v217, v200
    v_mfma_f32_16x16x32_bf16 v[4:7], a[164:167], v[208:211], v[4:7]
    buffer_load_dwordx4 v225, s[8:11], s22 offen offset:1056 nt lds
    v_exp_f32 v202, v202
    v_mfma_f32_16x16x32_bf16 v[8:11], a[232:235], v[244:247], v[8:11]
    v_add_f32 v217, v217, v201
    v_cvt_pk_bf16_f32 v232, v200, v201
    v_mfma_f32_16x16x32_bf16 v[8:11], a[168:171], v[208:211], v[8:11]
    v_exp_f32 v203, v203
    v_mfma_f32_16x16x32_bf16 v[12:15], a[236:239], v[244:247], v[12:15]
    ds_read_b64_tr_b16 a[192:193], v223 offset:16896
    v_add_f32 v217, v217, v202
    v_mfma_f32_16x16x32_bf16 v[12:15], a[172:175], v[208:211], v[12:15]
    v_exp_f32 v204, v204
    v_mfma_f32_16x16x32_bf16 v[192:195], a[96:99], a[32:35], 0
    v_add_f32 v217, v217, v203
    v_cvt_pk_bf16_f32 v233, v202, v203
    v_mfma_f32_16x16x32_bf16 v[192:195], a[100:103], a[36:39], v[192:195]
    v_exp_f32 v205, v205
    v_mfma_f32_16x16x32_bf16 v[192:195], a[104:107], a[40:43], v[192:195]
    ds_read_b64_tr_b16 a[194:195], v223 offset:25344
    v_add_f32 v217, v217, v204
    v_mfma_f32_16x16x32_bf16 v[192:195], a[108:111], a[44:47], v[192:195]
    v_exp_f32 v206, v206
    v_mfma_f32_16x16x32_bf16 v[196:199], a[124:127], a[44:47], 0
    v_add_f32 v217, v217, v205
    v_cvt_pk_bf16_f32 v234, v204, v205
    v_mfma_f32_16x16x32_bf16 v[196:199], a[120:123], a[40:43], v[196:199]
    v_exp_f32 v207, v207
    v_mfma_f32_16x16x32_bf16 v[196:199], a[116:119], a[36:39], v[196:199]
    ds_read_b64_tr_b16 a[196:197], v223 offset:16928
    v_add_f32 v217, v217, v206
    v_mfma_f32_16x16x32_bf16 v[196:199], a[112:115], a[32:35], v[196:199]
    v_add_f32 v217, v217, v207
    v_cvt_pk_bf16_f32 v235, v206, v207
    v_mfma_f32_16x16x32_bf16 v[204:207], a[112:115], a[48:51], 0
    v_exp_f32 v192, v192
    v_mfma_f32_16x16x32_bf16 v[204:207], a[116:119], a[52:55], v[204:207]
    v_exp_f32 v193, v193
    v_mfma_f32_16x16x32_bf16 v[204:207], a[120:123], a[56:59], v[204:207]
    ds_read_b128 a[148:151], v222 offset:25600
    v_add_f32 v218, v218, v192
    v_mfma_f32_16x16x32_bf16 v[204:207], a[124:127], a[60:63], v[204:207]
    buffer_load_dwordx4 v224, s[12:15], s22 offen offset:2112 nt lds
    v_exp_f32 v194, v194
    v_mfma_f32_16x16x32_bf16 v[200:203], a[108:111], a[60:63], 0
    v_add_f32 v218, v218, v193
    v_cvt_pk_bf16_f32 v212, v192, v193
    v_mfma_f32_16x16x32_bf16 v[200:203], a[104:107], a[56:59], v[200:203]
    v_exp_f32 v195, v195
    v_mfma_f32_16x16x32_bf16 v[200:203], a[100:103], a[52:55], v[200:203]
    ds_read_b64_tr_b16 a[198:199], v223 offset:25376
    v_add_f32 v218, v218, v194
    v_mfma_f32_16x16x32_bf16 v[200:203], a[96:99], a[48:51], v[200:203]
    v_exp_f32 v196, v196
    v_mfma_f32_16x16x32_bf16 v[16:19], a[240:243], v[244:247], v[16:19]
    v_add_f32 v218, v218, v195
    v_cvt_pk_bf16_f32 v213, v194, v195
    v_mfma_f32_16x16x32_bf16 v[16:19], a[176:179], v[208:211], v[16:19]
    v_exp_f32 v197, v197
    v_mfma_f32_16x16x32_bf16 v[20:23], a[244:247], v[244:247], v[20:23]
    ds_read_b64_tr_b16 a[200:201], v223 offset:17152
    v_add_f32 v218, v218, v196
    v_mfma_f32_16x16x32_bf16 v[20:23], a[180:183], v[208:211], v[20:23]
    v_exp_f32 v198, v198
    v_mfma_f32_16x16x32_bf16 v[24:27], a[248:251], v[244:247], v[24:27]
    v_add_f32 v218, v218, v197
    v_cvt_pk_bf16_f32 v214, v196, v197
    v_mfma_f32_16x16x32_bf16 v[24:27], a[184:187], v[208:211], v[24:27]
    v_exp_f32 v199, v199
    v_mfma_f32_16x16x32_bf16 v[28:31], a[252:255], v[244:247], v[28:31]
    v_cvt_pk_bf16_f32 v215, v198, v199
    v_add_f32 v218, v218, v198
    v_mfma_f32_16x16x32_bf16 v[28:31], a[188:191], v[208:211], v[28:31]
    ds_read_b64_tr_b16 a[202:203], v223 offset:25600
    v_add_f32 v218, v218, v199
    v_mfma_f32_16x16x32_bf16 v[92:95], a[188:191], v[212:215], v[92:95]
    v_exp_f32 v200, v200
    v_mfma_f32_16x16x32_bf16 v[92:95], a[252:255], v[248:251], v[92:95]
    v_exp_f32 v201, v201
    v_mfma_f32_16x16x32_bf16 v[88:91], a[248:251], v[248:251], v[88:91]
    ds_read_b128 a[152:155], v222 offset:25856
    v_add_f32 v219, v219, v200
    v_mfma_f32_16x16x32_bf16 v[88:91], a[184:187], v[212:215], v[88:91]
    buffer_load_dwordx4 v225, s[12:15], s22 offen offset:3168 nt lds
    v_exp_f32 v202, v202
    v_mfma_f32_16x16x32_bf16 v[84:87], a[244:247], v[248:251], v[84:87]
    v_add_f32 v219, v219, v201
    v_cvt_pk_bf16_f32 v236, v200, v201
    v_mfma_f32_16x16x32_bf16 v[84:87], a[180:183], v[212:215], v[84:87]
    s_add_u32 s22, s22, 8192
    v_exp_f32 v203, v203
    v_mfma_f32_16x16x32_bf16 v[80:83], a[240:243], v[248:251], v[80:83]
    ds_read_b64_tr_b16 a[204:205], v223 offset:17184
    v_add_f32 v219, v219, v202
    v_mfma_f32_16x16x32_bf16 v[80:83], a[176:179], v[212:215], v[80:83]
    v_exp_f32 v204, v204
    v_mfma_f32_16x16x32_bf16 v[192:195], a[96:99], a[64:67], 0
    v_add_f32 v219, v219, v203
    v_cvt_pk_bf16_f32 v237, v202, v203
    v_mfma_f32_16x16x32_bf16 v[192:195], a[100:103], a[68:71], v[192:195]
    v_exp_f32 v205, v205
    v_mfma_f32_16x16x32_bf16 v[192:195], a[104:107], a[72:75], v[192:195]
    ds_read_b64_tr_b16 a[206:207], v223 offset:25632
    v_add_f32 v219, v219, v204
    v_mfma_f32_16x16x32_bf16 v[192:195], a[108:111], a[76:79], v[192:195]
    v_exp_f32 v206, v206
    v_mfma_f32_16x16x32_bf16 v[196:199], a[124:127], a[76:79], 0
    v_add_f32 v219, v219, v205
    v_cvt_pk_bf16_f32 v238, v204, v205
    v_mfma_f32_16x16x32_bf16 v[196:199], a[120:123], a[72:75], v[196:199]
    v_exp_f32 v207, v207
    v_mfma_f32_16x16x32_bf16 v[196:199], a[116:119], a[68:71], v[196:199]
    ds_read_b64_tr_b16 a[208:209], v223 offset:17408
    v_add_f32 v219, v219, v206
    v_mfma_f32_16x16x32_bf16 v[196:199], a[112:115], a[64:67], v[196:199]
    v_add_f32 v219, v219, v207
    v_cvt_pk_bf16_f32 v239, v206, v207
    v_mfma_f32_16x16x32_bf16 v[204:207], a[112:115], a[80:83], 0
    v_exp_f32 v192, v192
    v_mfma_f32_16x16x32_bf16 v[204:207], a[116:119], a[84:87], v[204:207]
    v_exp_f32 v193, v193
    v_mfma_f32_16x16x32_bf16 v[204:207], a[120:123], a[88:91], v[204:207]
    ds_read_b128 a[156:159], v222 offset:26112
    v_add_f32 v220, v220, v192
    v_mfma_f32_16x16x32_bf16 v[204:207], a[124:127], a[92:95], v[204:207]
    v_exp_f32 v194, v194
    v_mfma_f32_16x16x32_bf16 v[200:203], a[108:111], a[92:95], 0
    v_add_f32 v220, v220, v193
    v_cvt_pk_bf16_f32 v208, v192, v193
    v_mfma_f32_16x16x32_bf16 v[200:203], a[104:107], a[88:91], v[200:203]
    v_exp_f32 v195, v195
    v_mfma_f32_16x16x32_bf16 v[200:203], a[100:103], a[84:87], v[200:203]
    ds_read_b64_tr_b16 a[210:211], v223 offset:25856
    v_add_f32 v220, v220, v194
    v_mfma_f32_16x16x32_bf16 v[200:203], a[96:99], a[80:83], v[200:203]
    v_exp_f32 v196, v196
    v_mfma_f32_16x16x32_bf16 v[76:79], a[236:239], v[248:251], v[76:79]
    v_add_f32 v220, v220, v195
    v_cvt_pk_bf16_f32 v209, v194, v195
    v_mfma_f32_16x16x32_bf16 v[76:79], a[172:175], v[212:215], v[76:79]
    v_exp_f32 v197, v197
    v_mfma_f32_16x16x32_bf16 v[72:75], a[232:235], v[248:251], v[72:75]
    ds_read_b64_tr_b16 a[212:213], v223 offset:17440
    v_add_f32 v220, v220, v196
    v_mfma_f32_16x16x32_bf16 v[72:75], a[168:171], v[212:215], v[72:75]
    v_exp_f32 v198, v198
    v_mfma_f32_16x16x32_bf16 v[68:71], a[228:231], v[248:251], v[68:71]
    v_add_f32 v220, v220, v197
    v_cvt_pk_bf16_f32 v210, v196, v197
    v_mfma_f32_16x16x32_bf16 v[68:71], a[164:167], v[212:215], v[68:71]
    v_exp_f32 v199, v199
    v_mfma_f32_16x16x32_bf16 v[64:67], a[224:227], v[248:251], v[64:67]
    v_cvt_pk_bf16_f32 v211, v198, v199
    v_add_f32 v220, v220, v198
    v_mfma_f32_16x16x32_bf16 v[64:67], a[160:163], v[212:215], v[64:67]
    ds_read_b64_tr_b16 a[214:215], v223 offset:25888
    v_add_f32 v220, v220, v199
    v_mfma_f32_16x16x32_bf16 v[128:131], a[160:163], v[208:211], v[128:131]
    v_exp_f32 v200, v200
    v_mfma_f32_16x16x32_bf16 v[128:131], a[224:227], v[252:255], v[128:131]
    v_exp_f32 v201, v201
    v_mfma_f32_16x16x32_bf16 v[132:135], a[228:231], v[252:255], v[132:135]
    ds_read_b64_tr_b16 a[216:217], v223 offset:17664
    v_add_f32 v221, v221, v200
    v_mfma_f32_16x16x32_bf16 v[132:135], a[164:167], v[208:211], v[132:135]
    v_exp_f32 v202, v202
    v_mfma_f32_16x16x32_bf16 v[136:139], a[232:235], v[252:255], v[136:139]
    s_waitcnt lgkmcnt(4)
    v_add_f32 v221, v221, v201
    v_cvt_pk_bf16_f32 v240, v200, v201
    v_mfma_f32_16x16x32_bf16 v[136:139], a[168:171], v[208:211], v[136:139]
    v_exp_f32 v203, v203
    v_mfma_f32_16x16x32_bf16 v[140:143], a[236:239], v[252:255], v[140:143]
    ds_read_b64_tr_b16 a[218:219], v223 offset:26112
    v_add_f32 v221, v221, v202
    v_mfma_f32_16x16x32_bf16 v[140:143], a[172:175], v[208:211], v[140:143]
    v_exp_f32 v204, v204
    v_mfma_f32_16x16x32_bf16 v[192:195], a[128:131], a[16:19], 0
    v_add_f32 v221, v221, v203
    v_cvt_pk_bf16_f32 v241, v202, v203
    v_mfma_f32_16x16x32_bf16 v[192:195], a[132:135], a[20:23], v[192:195]
    v_exp_f32 v205, v205
    v_mfma_f32_16x16x32_bf16 v[192:195], a[136:139], a[24:27], v[192:195]
    ds_read_b64_tr_b16 a[220:221], v223 offset:17696
    v_add_f32 v221, v221, v204
    v_mfma_f32_16x16x32_bf16 v[192:195], a[140:143], a[28:31], v[192:195]
    v_exp_f32 v206, v206
    v_mfma_f32_16x16x32_bf16 v[196:199], a[156:159], a[28:31], 0
    v_add_f32 v221, v221, v205
    v_cvt_pk_bf16_f32 v242, v204, v205
    v_mfma_f32_16x16x32_bf16 v[196:199], a[152:155], a[24:27], v[196:199]
    v_exp_f32 v207, v207
    v_mfma_f32_16x16x32_bf16 v[196:199], a[148:151], a[20:23], v[196:199]
    ds_read_b64_tr_b16 a[222:223], v223 offset:26144
    v_add_f32 v221, v221, v206
    v_mfma_f32_16x16x32_bf16 v[196:199], a[144:147], a[16:19], v[196:199]
    v_add_f32 v221, v221, v207
    v_cvt_pk_bf16_f32 v243, v206, v207
    v_mfma_f32_16x16x32_bf16 v[204:207], a[144:147], a[0:3], 0
    s_waitcnt vmcnt(4)
    s_barrier
    v_exp_f32 v192, v192
    v_mfma_f32_16x16x32_bf16 v[204:207], a[148:151], a[4:7], v[204:207]
    s_add_u32 m0, s21, 67584
    v_exp_f32 v193, v193
    v_mfma_f32_16x16x32_bf16 v[204:207], a[152:155], a[8:11], v[204:207]
    ds_read_b128 a[96:99], v222 offset:33792
    v_add_f32 v217, v217, v192
    v_mfma_f32_16x16x32_bf16 v[204:207], a[156:159], a[12:15], v[204:207]
    buffer_load_dwordx4 v224, s[8:11], s22 offen nt lds
    v_exp_f32 v194, v194
    v_mfma_f32_16x16x32_bf16 v[200:203], a[140:143], a[12:15], 0
    v_add_f32 v217, v217, v193
    v_cvt_pk_bf16_f32 v212, v192, v193
    v_mfma_f32_16x16x32_bf16 v[200:203], a[136:139], a[8:11], v[200:203]
    v_exp_f32 v195, v195
    v_mfma_f32_16x16x32_bf16 v[200:203], a[132:135], a[4:7], v[200:203]
    ds_read_b128 a[100:103], v222 offset:34048
    v_add_f32 v217, v217, v194
    v_mfma_f32_16x16x32_bf16 v[200:203], a[128:131], a[0:3], v[200:203]
    v_exp_f32 v196, v196
    v_mfma_f32_16x16x32_bf16 v[144:147], a[240:243], v[252:255], v[144:147]
    v_add_f32 v217, v217, v195
    v_cvt_pk_bf16_f32 v213, v194, v195
    v_mfma_f32_16x16x32_bf16 v[144:147], a[176:179], v[208:211], v[144:147]
    v_exp_f32 v197, v197
    v_mfma_f32_16x16x32_bf16 v[148:151], a[244:247], v[252:255], v[148:151]
    ds_read_b128 a[104:107], v222 offset:34304
    v_add_f32 v217, v217, v196
    v_mfma_f32_16x16x32_bf16 v[148:151], a[180:183], v[208:211], v[148:151]
    v_exp_f32 v198, v198
    v_mfma_f32_16x16x32_bf16 v[152:155], a[248:251], v[252:255], v[152:155]
    v_add_f32 v217, v217, v197
    v_cvt_pk_bf16_f32 v214, v196, v197
    v_mfma_f32_16x16x32_bf16 v[152:155], a[184:187], v[208:211], v[152:155]
    v_exp_f32 v199, v199
    v_mfma_f32_16x16x32_bf16 v[156:159], a[252:255], v[252:255], v[156:159]
    v_cvt_pk_bf16_f32 v215, v198, v199
    v_add_f32 v217, v217, v198
    v_mfma_f32_16x16x32_bf16 v[156:159], a[188:191], v[208:211], v[156:159]
    s_waitcnt lgkmcnt(3)
    ds_read_b128 a[108:111], v222 offset:34560
    v_add_f32 v217, v217, v199
    v_mfma_f32_16x16x32_bf16 v[60:63], a[188:191], v[232:235], v[60:63]
    v_exp_f32 v200, v200
    v_mfma_f32_16x16x32_bf16 v[60:63], a[220:223], v[212:215], v[60:63]
    v_exp_f32 v201, v201
    v_mfma_f32_16x16x32_bf16 v[56:59], a[184:187], v[232:235], v[56:59]
    ds_read_b128 a[112:115], v222 offset:42240
    v_add_f32 v216, v216, v200
    v_mfma_f32_16x16x32_bf16 v[56:59], a[216:219], v[212:215], v[56:59]
    buffer_load_dwordx4 v225, s[8:11], s22 offen offset:1056 nt lds
    v_exp_f32 v202, v202
    v_mfma_f32_16x16x32_bf16 v[52:55], a[180:183], v[232:235], v[52:55]
    v_add_f32 v216, v216, v201
    v_cvt_pk_bf16_f32 v244, v200, v201
    v_mfma_f32_16x16x32_bf16 v[52:55], a[212:215], v[212:215], v[52:55]
    v_exp_f32 v203, v203
    v_mfma_f32_16x16x32_bf16 v[48:51], a[176:179], v[232:235], v[48:51]
    ds_read_b64_tr_b16 a[224:225], v223 offset:33792
    v_add_f32 v216, v216, v202
    v_mfma_f32_16x16x32_bf16 v[48:51], a[208:211], v[212:215], v[48:51]
    v_exp_f32 v204, v204
    v_mfma_f32_16x16x32_bf16 v[192:195], a[128:131], a[48:51], 0
    v_add_f32 v216, v216, v203
    v_cvt_pk_bf16_f32 v245, v202, v203
    v_mfma_f32_16x16x32_bf16 v[192:195], a[132:135], a[52:55], v[192:195]
    v_exp_f32 v205, v205
    v_mfma_f32_16x16x32_bf16 v[192:195], a[136:139], a[56:59], v[192:195]
    ds_read_b64_tr_b16 a[226:227], v223 offset:42240
    v_add_f32 v216, v216, v204
    v_mfma_f32_16x16x32_bf16 v[192:195], a[140:143], a[60:63], v[192:195]
    v_exp_f32 v206, v206
    v_mfma_f32_16x16x32_bf16 v[196:199], a[156:159], a[60:63], 0
    v_add_f32 v216, v216, v205
    v_cvt_pk_bf16_f32 v246, v204, v205
    v_mfma_f32_16x16x32_bf16 v[196:199], a[152:155], a[56:59], v[196:199]
    v_exp_f32 v207, v207
    v_mfma_f32_16x16x32_bf16 v[196:199], a[148:151], a[52:55], v[196:199]
    ds_read_b64_tr_b16 a[228:229], v223 offset:33824
    v_add_f32 v216, v216, v206
    v_mfma_f32_16x16x32_bf16 v[196:199], a[144:147], a[48:51], v[196:199]
    v_add_f32 v216, v216, v207
    v_cvt_pk_bf16_f32 v247, v206, v207
    v_mfma_f32_16x16x32_bf16 v[204:207], a[144:147], a[32:35], 0
    v_exp_f32 v192, v192
    v_mfma_f32_16x16x32_bf16 v[204:207], a[148:151], a[36:39], v[204:207]
    v_exp_f32 v193, v193
    v_mfma_f32_16x16x32_bf16 v[204:207], a[152:155], a[40:43], v[204:207]
    ds_read_b128 a[116:119], v222 offset:42496
    v_add_f32 v219, v219, v192
    v_mfma_f32_16x16x32_bf16 v[204:207], a[156:159], a[44:47], v[204:207]
    buffer_load_dwordx4 v224, s[12:15], s22 offen offset:2112 nt lds
    v_exp_f32 v194, v194
    v_mfma_f32_16x16x32_bf16 v[200:203], a[140:143], a[44:47], 0
    v_add_f32 v219, v219, v193
    v_cvt_pk_bf16_f32 v208, v192, v193
    v_mfma_f32_16x16x32_bf16 v[200:203], a[136:139], a[40:43], v[200:203]
    v_exp_f32 v195, v195
    v_mfma_f32_16x16x32_bf16 v[200:203], a[132:135], a[36:39], v[200:203]
    ds_read_b64_tr_b16 a[230:231], v223 offset:42272
    v_add_f32 v219, v219, v194
    v_mfma_f32_16x16x32_bf16 v[200:203], a[128:131], a[32:35], v[200:203]
    v_exp_f32 v196, v196
    v_mfma_f32_16x16x32_bf16 v[44:47], a[172:175], v[232:235], v[44:47]
    v_add_f32 v219, v219, v195
    v_cvt_pk_bf16_f32 v209, v194, v195
    v_mfma_f32_16x16x32_bf16 v[44:47], a[204:207], v[212:215], v[44:47]
    v_exp_f32 v197, v197
    v_mfma_f32_16x16x32_bf16 v[40:43], a[168:171], v[232:235], v[40:43]
    ds_read_b64_tr_b16 a[232:233], v223 offset:34048
    v_add_f32 v219, v219, v196
    v_mfma_f32_16x16x32_bf16 v[40:43], a[200:203], v[212:215], v[40:43]
    v_exp_f32 v198, v198
    v_mfma_f32_16x16x32_bf16 v[36:39], a[164:167], v[232:235], v[36:39]
    v_add_f32 v219, v219, v197
    v_cvt_pk_bf16_f32 v210, v196, v197
    v_mfma_f32_16x16x32_bf16 v[36:39], a[196:199], v[212:215], v[36:39]
    v_exp_f32 v199, v199
    v_mfma_f32_16x16x32_bf16 v[32:35], a[160:163], v[232:235], v[32:35]
    v_cvt_pk_bf16_f32 v211, v198, v199
    v_add_f32 v219, v219, v198
    v_mfma_f32_16x16x32_bf16 v[32:35], a[192:195], v[212:215], v[32:35]
    ds_read_b64_tr_b16 a[234:235], v223 offset:42496
    v_add_f32 v219, v219, v199
    v_mfma_f32_16x16x32_bf16 v[96:99], a[192:195], v[208:211], v[96:99]
    v_exp_f32 v200, v200
    v_mfma_f32_16x16x32_bf16 v[96:99], a[160:163], v[236:239], v[96:99]
    v_exp_f32 v201, v201
    v_mfma_f32_16x16x32_bf16 v[100:103], a[164:167], v[236:239], v[100:103]
    ds_read_b128 a[120:123], v222 offset:42752
    v_add_f32 v218, v218, v200
    v_mfma_f32_16x16x32_bf16 v[100:103], a[196:199], v[208:211], v[100:103]
    buffer_load_dwordx4 v225, s[12:15], s22 offen offset:3168 nt lds
    v_exp_f32 v202, v202
    v_mfma_f32_16x16x32_bf16 v[104:107], a[168:171], v[236:239], v[104:107]
    v_add_f32 v218, v218, v201
    v_cvt_pk_bf16_f32 v248, v200, v201
    v_mfma_f32_16x16x32_bf16 v[104:107], a[200:203], v[208:211], v[104:107]
    s_add_u32 s22, s22, 8192
    v_exp_f32 v203, v203
    v_mfma_f32_16x16x32_bf16 v[108:111], a[172:175], v[236:239], v[108:111]
    ds_read_b64_tr_b16 a[236:237], v223 offset:34080
    v_add_f32 v218, v218, v202
    v_mfma_f32_16x16x32_bf16 v[108:111], a[204:207], v[208:211], v[108:111]
    v_exp_f32 v204, v204
    v_mfma_f32_16x16x32_bf16 v[192:195], a[128:131], a[80:83], 0
    v_add_f32 v218, v218, v203
    v_cvt_pk_bf16_f32 v249, v202, v203
    v_mfma_f32_16x16x32_bf16 v[192:195], a[132:135], a[84:87], v[192:195]
    v_exp_f32 v205, v205
    v_mfma_f32_16x16x32_bf16 v[192:195], a[136:139], a[88:91], v[192:195]
    ds_read_b64_tr_b16 a[238:239], v223 offset:42528
    v_add_f32 v218, v218, v204
    v_mfma_f32_16x16x32_bf16 v[192:195], a[140:143], a[92:95], v[192:195]
    v_exp_f32 v206, v206
    v_mfma_f32_16x16x32_bf16 v[196:199], a[156:159], a[92:95], 0
    v_add_f32 v218, v218, v205
    v_cvt_pk_bf16_f32 v250, v204, v205
    v_mfma_f32_16x16x32_bf16 v[196:199], a[152:155], a[88:91], v[196:199]
    v_exp_f32 v207, v207
    v_mfma_f32_16x16x32_bf16 v[196:199], a[148:151], a[84:87], v[196:199]
    ds_read_b64_tr_b16 a[240:241], v223 offset:34304
    v_add_f32 v218, v218, v206
    v_mfma_f32_16x16x32_bf16 v[196:199], a[144:147], a[80:83], v[196:199]
    v_add_f32 v218, v218, v207
    v_cvt_pk_bf16_f32 v251, v206, v207
    v_mfma_f32_16x16x32_bf16 v[204:207], a[144:147], a[64:67], 0
    v_exp_f32 v192, v192
    v_mfma_f32_16x16x32_bf16 v[204:207], a[148:151], a[68:71], v[204:207]
    v_exp_f32 v193, v193
    v_mfma_f32_16x16x32_bf16 v[204:207], a[152:155], a[72:75], v[204:207]
    ds_read_b128 a[124:127], v222 offset:43008
    v_add_f32 v221, v221, v192
    v_mfma_f32_16x16x32_bf16 v[204:207], a[156:159], a[76:79], v[204:207]
    v_exp_f32 v194, v194
    v_mfma_f32_16x16x32_bf16 v[200:203], a[140:143], a[76:79], 0
    v_add_f32 v221, v221, v193
    v_cvt_pk_bf16_f32 v212, v192, v193
    v_mfma_f32_16x16x32_bf16 v[200:203], a[136:139], a[72:75], v[200:203]
    v_exp_f32 v195, v195
    v_mfma_f32_16x16x32_bf16 v[200:203], a[132:135], a[68:71], v[200:203]
    ds_read_b64_tr_b16 a[242:243], v223 offset:42752
    v_add_f32 v221, v221, v194
    v_mfma_f32_16x16x32_bf16 v[200:203], a[128:131], a[64:67], v[200:203]
    v_exp_f32 v196, v196
    v_mfma_f32_16x16x32_bf16 v[112:115], a[176:179], v[236:239], v[112:115]
    v_add_f32 v221, v221, v195
    v_cvt_pk_bf16_f32 v213, v194, v195
    v_mfma_f32_16x16x32_bf16 v[112:115], a[208:211], v[208:211], v[112:115]
    v_exp_f32 v197, v197
    v_mfma_f32_16x16x32_bf16 v[116:119], a[180:183], v[236:239], v[116:119]
    ds_read_b64_tr_b16 a[244:245], v223 offset:34336
    v_add_f32 v221, v221, v196
    v_mfma_f32_16x16x32_bf16 v[116:119], a[212:215], v[208:211], v[116:119]
    v_exp_f32 v198, v198
    v_mfma_f32_16x16x32_bf16 v[120:123], a[184:187], v[236:239], v[120:123]
    v_add_f32 v221, v221, v197
    v_cvt_pk_bf16_f32 v214, v196, v197
    v_mfma_f32_16x16x32_bf16 v[120:123], a[216:219], v[208:211], v[120:123]
    v_exp_f32 v199, v199
    v_mfma_f32_16x16x32_bf16 v[124:127], a[188:191], v[236:239], v[124:127]
    v_cvt_pk_bf16_f32 v215, v198, v199
    v_add_f32 v221, v221, v198
    v_mfma_f32_16x16x32_bf16 v[124:127], a[220:223], v[208:211], v[124:127]
    ds_read_b64_tr_b16 a[246:247], v223 offset:42784
    v_add_f32 v221, v221, v199
    v_mfma_f32_16x16x32_bf16 v[188:191], a[220:223], v[212:215], v[188:191]
    v_exp_f32 v200, v200
    v_mfma_f32_16x16x32_bf16 v[188:191], a[188:191], v[240:243], v[188:191]
    v_exp_f32 v201, v201
    v_mfma_f32_16x16x32_bf16 v[184:187], a[184:187], v[240:243], v[184:187]
    ds_read_b64_tr_b16 a[248:249], v223 offset:34560
    v_add_f32 v220, v220, v200
    v_mfma_f32_16x16x32_bf16 v[184:187], a[216:219], v[212:215], v[184:187]
    s_sub_u32 s23, s23, 1
    v_exp_f32 v202, v202
    v_mfma_f32_16x16x32_bf16 v[180:183], a[180:183], v[240:243], v[180:183]
    s_waitcnt lgkmcnt(4)
    v_add_f32 v220, v220, v201
    v_cvt_pk_bf16_f32 v252, v200, v201
    v_mfma_f32_16x16x32_bf16 v[180:183], a[212:215], v[212:215], v[180:183]
    s_cmp_lg_u32 s23, 0
    v_exp_f32 v203, v203
    v_mfma_f32_16x16x32_bf16 v[176:179], a[176:179], v[240:243], v[176:179]
    ds_read_b64_tr_b16 a[250:251], v223 offset:43008
    v_add_f32 v220, v220, v202
    v_mfma_f32_16x16x32_bf16 v[176:179], a[208:211], v[212:215], v[176:179]
    v_exp_f32 v204, v204
    v_mfma_f32_16x16x32_bf16 v[192:195], a[96:99], a[0:3], 0
    v_add_f32 v220, v220, v203
    v_cvt_pk_bf16_f32 v253, v202, v203
    v_mfma_f32_16x16x32_bf16 v[192:195], a[100:103], a[4:7], v[192:195]
    v_exp_f32 v205, v205
    v_mfma_f32_16x16x32_bf16 v[192:195], a[104:107], a[8:11], v[192:195]
    ds_read_b64_tr_b16 a[252:253], v223 offset:34592
    v_add_f32 v220, v220, v204
    v_mfma_f32_16x16x32_bf16 v[192:195], a[108:111], a[12:15], v[192:195]
    v_exp_f32 v206, v206
    v_mfma_f32_16x16x32_bf16 v[196:199], a[124:127], a[12:15], 0
    v_add_f32 v220, v220, v205
    v_cvt_pk_bf16_f32 v254, v204, v205
    v_mfma_f32_16x16x32_bf16 v[196:199], a[120:123], a[8:11], v[196:199]
    v_exp_f32 v207, v207
    v_mfma_f32_16x16x32_bf16 v[196:199], a[116:119], a[4:7], v[196:199]
    ds_read_b64_tr_b16 a[254:255], v223 offset:43040
    v_add_f32 v220, v220, v206
    v_mfma_f32_16x16x32_bf16 v[196:199], a[112:115], a[0:3], v[196:199]
    v_add_f32 v220, v220, v207
    v_cvt_pk_bf16_f32 v255, v206, v207
    s_cbranch_scc1 L_loop
L_last:
    v_mfma_f32_16x16x32_bf16 v[200:203], a[96:99], a[16:19], 0
    s_waitcnt vmcnt(4)
    s_barrier
    v_exp_f32 v192, v192
    v_mfma_f32_16x16x32_bf16 v[200:203], a[100:103], a[20:23], v[200:203]
    ds_read_b128 a[144:147], v228 offset:8448
    v_exp_f32 v193, v193
    v_mfma_f32_16x16x32_bf16 v[200:203], a[104:107], a[24:27], v[200:203]
    ds_read_b128 a[128:131], v228 offset:0
    v_add_f32 v216, v216, v192
    v_mfma_f32_16x16x32_bf16 v[200:203], a[108:111], a[28:31], v[200:203]
    ds_read_b128 a[148:151], v228 offset:8704
    v_exp_f32 v194, v194
    v_mfma_f32_16x16x32_bf16 v[204:207], a[124:127], a[28:31], 0
    v_add_f32 v216, v216, v193
    v_cvt_pk_bf16_f32 v208, v192, v193
    v_mfma_f32_16x16x32_bf16 v[204:207], a[120:123], a[24:27], v[204:207]
    ds_read_b128 a[152:155], v228 offset:8960
    v_exp_f32 v195, v195
    v_mfma_f32_16x16x32_bf16 v[204:207], a[116:119], a[20:23], v[204:207]
    ds_read_b128 a[132:135], v228 offset:256
    v_add_f32 v216, v216, v194
    v_mfma_f32_16x16x32_bf16 v[204:207], a[112:115], a[16:19], v[204:207]
    ds_read_b128 a[156:159], v228 offset:9216
    v_exp_f32 v196, v196
    v_mfma_f32_16x16x32_bf16 v[172:175], a[172:175], v[240:243], v[172:175]
    v_add_f32 v216, v216, v195
    v_cvt_pk_bf16_f32 v209, v194, v195
    v_mfma_f32_16x16x32_bf16 v[172:175], a[204:207], v[212:215], v[172:175]
    v_exp_f32 v197, v197
    v_mfma_f32_16x16x32_bf16 v[168:171], a[168:171], v[240:243], v[168:171]
    ds_read_b128 a[136:139], v228 offset:512
    v_add_f32 v216, v216, v196
    v_mfma_f32_16x16x32_bf16 v[168:171], a[200:203], v[212:215], v[168:171]
    v_exp_f32 v198, v198
    v_mfma_f32_16x16x32_bf16 v[164:167], a[164:167], v[240:243], v[164:167]
    v_add_f32 v216, v216, v197
    v_cvt_pk_bf16_f32 v210, v196, v197
    v_mfma_f32_16x16x32_bf16 v[164:167], a[196:199], v[212:215], v[164:167]
    v_exp_f32 v199, v199
    v_mfma_f32_16x16x32_bf16 v[160:163], a[160:163], v[240:243], v[160:163]
    ds_read_b128 a[140:143], v228 offset:768
    v_add_f32 v216, v216, v198
    v_mfma_f32_16x16x32_bf16 v[160:163], a[192:195], v[212:215], v[160:163]
    v_add_f32 v216, v216, v199
    v_cvt_pk_bf16_f32 v211, v198, v199
    s_waitcnt lgkmcnt(0)
    v_mfma_f32_16x16x32_bf16 v[192:195], a[128:131], a[0:3], 0
    v_exp_f32 v200, v200
    v_mfma_f32_16x16x32_bf16 v[192:195], a[132:135], a[4:7], v[192:195]
    ds_read_b64_tr_b16 a[168:169], v229 offset:256
    v_exp_f32 v201, v201
    v_mfma_f32_16x16x32_bf16 v[192:195], a[136:139], a[8:11], v[192:195]
    ds_read_b64_tr_b16 a[160:161], v229 offset:0
    v_add_f32 v217, v217, v200
    v_mfma_f32_16x16x32_bf16 v[192:195], a[140:143], a[12:15], v[192:195]
    ds_read_b64_tr_b16 a[170:171], v229 offset:8704
    v_exp_f32 v202, v202
    v_mfma_f32_16x16x32_bf16 v[196:199], a[156:159], a[12:15], 0
    v_add_f32 v217, v217, v201
    v_cvt_pk_bf16_f32 v212, v200, v201
    v_mfma_f32_16x16x32_bf16 v[196:199], a[152:155], a[8:11], v[196:199]
    ds_read_b64_tr_b16 a[172:173], v229 offset:288
    v_exp_f32 v203, v203
    v_mfma_f32_16x16x32_bf16 v[196:199], a[148:151], a[4:7], v[196:199]
    ds_read_b64_tr_b16 a[162:163], v229 offset:8448
    v_add_f32 v217, v217, v202
    v_mfma_f32_16x16x32_bf16 v[196:199], a[144:147], a[0:3], v[196:199]
    ds_read_b64_tr_b16 a[174:175], v229 offset:8736
    v_exp_f32 v204, v204
    v_mfma_f32_16x16x32_bf16 v[0:3], a[192:195], v[244:247], v[0:3]
    v_add_f32 v217, v217, v203
    v_cvt_pk_bf16_f32 v213, v202, v203
    v_mfma_f32_16x16x32_bf16 v[0:3], a[224:227], v[208:211], v[0:3]
    v_exp_f32 v205, v205
    v_mfma_f32_16x16x32_bf16 v[4:7], a[196:199], v[244:247], v[4:7]
    ds_read_b64_tr_b16 a[164:165], v229 offset:32
    v_add_f32 v217, v217, v204
    v_mfma_f32_16x16x32_bf16 v[4:7], a[228:231], v[208:211], v[4:7]
    v_exp_f32 v206, v206
    v_mfma_f32_16x16x32_bf16 v[8:11], a[200:203], v[244:247], v[8:11]
    v_add_f32 v217, v217, v205
    v_cvt_pk_bf16_f32 v214, v204, v205
    v_mfma_f32_16x16x32_bf16 v[8:11], a[232:235], v[208:211], v[8:11]
    v_exp_f32 v207, v207
    v_mfma_f32_16x16x32_bf16 v[12:15], a[204:207], v[244:247], v[12:15]
    ds_read_b64_tr_b16 a[166:167], v229 offset:8480
    v_add_f32 v217, v217, v206
    v_mfma_f32_16x16x32_bf16 v[12:15], a[236:239], v[208:211], v[12:15]
    v_add_f32 v217, v217, v207
    v_cvt_pk_bf16_f32 v215, v206, v207
    v_mfma_f32_16x16x32_bf16 v[16:19], a[208:211], v[244:247], v[16:19]
    v_mfma_f32_16x16x32_bf16 v[16:19], a[240:243], v[208:211], v[16:19]
    v_mfma_f32_16x16x32_bf16 v[20:23], a[212:215], v[244:247], v[20:23]
    v_mfma_f32_16x16x32_bf16 v[20:23], a[244:247], v[208:211], v[20:23]
    v_mfma_f32_16x16x32_bf16 v[24:27], a[216:219], v[244:247], v[24:27]
    v_mfma_f32_16x16x32_bf16 v[24:27], a[248:251], v[208:211], v[24:27]
    v_mfma_f32_16x16x32_bf16 v[28:31], a[220:223], v[244:247], v[28:31]
    v_mfma_f32_16x16x32_bf16 v[28:31], a[252:255], v[208:211], v[28:31]
    v_mfma_f32_16x16x32_bf16 v[200:203], a[128:131], a[16:19], 0
    v_exp_f32 v192, v192
    v_mfma_f32_16x16x32_bf16 v[200:203], a[132:135], a[20:23], v[200:203]
    ds_read_b64_tr_b16 a[184:185], v229 offset:768
    v_exp_f32 v193, v193
    v_mfma_f32_16x16x32_bf16 v[200:203], a[136:139], a[24:27], v[200:203]
    ds_read_b64_tr_b16 a[176:177], v229 offset:512
    v_add_f32 v216, v216, v192
    v_mfma_f32_16x16x32_bf16 v[200:203], a[140:143], a[28:31], v[200:203]
    ds_read_b64_tr_b16 a[186:187], v229 offset:9216
    v_exp_f32 v194, v194
    v_mfma_f32_16x16x32_bf16 v[204:207], a[156:159], a[28:31], 0
    v_add_f32 v216, v216, v193
    v_cvt_pk_bf16_f32 v208, v192, v193
    v_mfma_f32_16x16x32_bf16 v[204:207], a[152:155], a[24:27], v[204:207]
    ds_read_b64_tr_b16 a[188:189], v229 offset:800
    v_exp_f32 v195, v195
    v_mfma_f32_16x16x32_bf16 v[204:207], a[148:151], a[20:23], v[204:207]
    ds_read_b64_tr_b16 a[178:179], v229 offset:8960
    v_add_f32 v216, v216, v194
    v_mfma_f32_16x16x32_bf16 v[204:207], a[144:147], a[16:19], v[204:207]
    ds_read_b64_tr_b16 a[190:191], v229 offset:9248
    v_exp_f32 v196, v196
    v_mfma_f32_16x16x32_bf16 v[32:35], a[224:227], v[212:215], v[32:35]
    v_add_f32 v216, v216, v195
    v_cvt_pk_bf16_f32 v209, v194, v195
    v_mfma_f32_16x16x32_bf16 v[36:39], a[228:231], v[212:215], v[36:39]
    v_exp_f32 v197, v197
    v_mfma_f32_16x16x32_bf16 v[40:43], a[232:235], v[212:215], v[40:43]
    ds_read_b64_tr_b16 a[180:181], v229 offset:544
    v_add_f32 v216, v216, v196
    v_mfma_f32_16x16x32_bf16 v[44:47], a[236:239], v[212:215], v[44:47]
    v_exp_f32 v198, v198
    v_mfma_f32_16x16x32_bf16 v[48:51], a[240:243], v[212:215], v[48:51]
    v_add_f32 v216, v216, v197
    v_cvt_pk_bf16_f32 v210, v196, v197
    v_mfma_f32_16x16x32_bf16 v[52:55], a[244:247], v[212:215], v[52:55]
    v_exp_f32 v199, v199
    v_mfma_f32_16x16x32_bf16 v[56:59], a[248:251], v[212:215], v[56:59]
    ds_read_b64_tr_b16 a[182:183], v229 offset:8992
    v_add_f32 v216, v216, v198
    v_mfma_f32_16x16x32_bf16 v[60:63], a[252:255], v[212:215], v[60:63]
    v_add_f32 v216, v216, v199
    v_cvt_pk_bf16_f32 v211, v198, v199
    v_mfma_f32_16x16x32_bf16 v[64:67], a[192:195], v[248:251], v[64:67]
    v_mfma_f32_16x16x32_bf16 v[68:71], a[196:199], v[248:251], v[68:71]
    v_mfma_f32_16x16x32_bf16 v[72:75], a[200:203], v[248:251], v[72:75]
    v_mfma_f32_16x16x32_bf16 v[76:79], a[204:207], v[248:251], v[76:79]
    v_mfma_f32_16x16x32_bf16 v[80:83], a[208:211], v[248:251], v[80:83]
    v_mfma_f32_16x16x32_bf16 v[84:87], a[212:215], v[248:251], v[84:87]
    v_mfma_f32_16x16x32_bf16 v[88:91], a[216:219], v[248:251], v[88:91]
    v_mfma_f32_16x16x32_bf16 v[92:95], a[220:223], v[248:251], v[92:95]
    v_mfma_f32_16x16x32_bf16 v[192:195], a[96:99], a[32:35], 0
    s_waitcnt lgkmcnt(0)
    v_exp_f32 v200, v200
    v_mfma_f32_16x16x32_bf16 v[192:195], a[100:103], a[36:39], v[192:195]
    v_exp_f32 v201, v201
    v_mfma_f32_16x16x32_bf16 v[192:195], a[104:107], a[40:43], v[192:195]
    v_add_f32 v217, v217, v200
    v_mov_b32 v232, v216
    v_mfma_f32_16x16x32_bf16 v[192:195], a[108:111], a[44:47], v[192:195]
    v_exp_f32 v202, v202
    v_mfma_f32_16x16x32_bf16 v[196:199], a[124:127], a[44:47], 0
    v_add_f32 v217, v217, v201
    v_cvt_pk_bf16_f32 v212, v200, v201
    v_permlane32_swap_b32 v216, v232
    v_mfma_f32_16x16x32_bf16 v[196:199], a[120:123], a[40:43], v[196:199]
    v_exp_f32 v203, v203
    v_mfma_f32_16x16x32_bf16 v[196:199], a[116:119], a[36:39], v[196:199]
    v_add_f32 v217, v217, v202
    v_add_f32 v216, v216, v232
    v_mfma_f32_16x16x32_bf16 v[196:199], a[112:115], a[32:35], v[196:199]
    v_exp_f32 v204, v204
    v_mfma_f32_16x16x32_bf16 v[0:3], a[160:163], v[208:211], v[0:3]
    v_add_f32 v217, v217, v203
    v_cvt_pk_bf16_f32 v213, v202, v203
    v_mfma_f32_16x16x32_bf16 v[4:7], a[164:167], v[208:211], v[4:7]
    v_exp_f32 v205, v205
    v_mov_b32 v232, v216
    v_mfma_f32_16x16x32_bf16 v[8:11], a[168:171], v[208:211], v[8:11]
    v_add_f32 v217, v217, v204
    v_mfma_f32_16x16x32_bf16 v[12:15], a[172:175], v[208:211], v[12:15]
    v_exp_f32 v206, v206
    v_permlane16_swap_b32 v216, v232
    v_mfma_f32_16x16x32_bf16 v[16:19], a[176:179], v[208:211], v[16:19]
    v_add_f32 v217, v217, v205
    v_cvt_pk_bf16_f32 v214, v204, v205
    v_mfma_f32_16x16x32_bf16 v[20:23], a[180:183], v[208:211], v[20:23]
    v_exp_f32 v207, v207
    v_add_f32 v216, v216, v232
    v_mfma_f32_16x16x32_bf16 v[24:27], a[184:187], v[208:211], v[24:27]
    v_add_f32 v217, v217, v206
    v_mfma_f32_16x16x32_bf16 v[28:31], a[188:191], v[208:211], v[28:31]
    v_add_f32 v217, v217, v207
    v_cvt_pk_bf16_f32 v215, v206, v207
    v_rcp_f32 v238, v216
    v_mfma_f32_16x16x32_bf16 v[128:131], a[192:195], v[252:255], v[128:131]
    v_mfma_f32_16x16x32_bf16 v[132:135], a[196:199], v[252:255], v[132:135]
    v_mfma_f32_16x16x32_bf16 v[136:139], a[200:203], v[252:255], v[136:139]
    v_mfma_f32_16x16x32_bf16 v[140:143], a[204:207], v[252:255], v[140:143]
    v_mfma_f32_16x16x32_bf16 v[144:147], a[208:211], v[252:255], v[144:147]
    v_mfma_f32_16x16x32_bf16 v[148:151], a[212:215], v[252:255], v[148:151]
    v_mfma_f32_16x16x32_bf16 v[152:155], a[216:219], v[252:255], v[152:155]
    v_mfma_f32_16x16x32_bf16 v[156:159], a[220:223], v[252:255], v[156:159]
    v_mfma_f32_16x16x32_bf16 v[200:203], a[128:131], a[32:35], 0
    v_exp_f32 v192, v192
    v_mov_b32 v252, 0
    v_mov_b32 v253, 0
    v_mov_b32 v254, 0
    v_mov_b32 v255, 0
    v_mfma_f32_16x16x32_bf16 v[200:203], a[132:135], a[36:39], v[200:203]
    v_exp_f32 v193, v193
    v_mov_b32 v233, v217
    s_nop 1
    v_permlane32_swap_b32 v217, v233
    v_add_f32 v217, v217, v233
    v_mov_b32 v233, v217
    v_mfma_f32_16x16x32_bf16 v[200:203], a[136:139], a[40:43], v[200:203]
    v_add_f32 v218, v218, v192
    v_permlane16_swap_b32 v217, v233
    v_add_f32 v217, v217, v233
    v_rcp_f32 v239, v217
    v_mul_f32 v0, v0, v238
    v_mul_f32 v1, v1, v238
    v_mfma_f32_16x16x32_bf16 v[200:203], a[140:143], a[44:47], v[200:203]
    v_exp_f32 v194, v194
    v_mul_f32 v2, v2, v238
    v_mul_f32 v3, v3, v238
    v_cvt_pk_bf16_f32 v0, v0, v1
    v_cvt_pk_bf16_f32 v1, v2, v3
    v_mfma_f32_16x16x32_bf16 v[204:207], a[156:159], a[44:47], 0
    v_add_f32 v218, v218, v193
    v_cvt_pk_bf16_f32 v208, v192, v193
    ds_write_b64 v230, v[0:1] offset:0
    v_mul_f32 v4, v4, v238
    v_mul_f32 v5, v5, v238
    v_mul_f32 v6, v6, v238
    v_mul_f32 v7, v7, v238
    v_mfma_f32_16x16x32_bf16 v[204:207], a[152:155], a[40:43], v[204:207]
    v_exp_f32 v195, v195
    v_cvt_pk_bf16_f32 v4, v4, v5
    v_cvt_pk_bf16_f32 v5, v6, v7
    ds_write_b64 v230, v[4:5] offset:32
    v_mul_f32 v8, v8, v238
    v_mfma_f32_16x16x32_bf16 v[204:207], a[148:151], a[36:39], v[204:207]
    v_add_f32 v218, v218, v194
    v_mul_f32 v9, v9, v238
    v_mul_f32 v10, v10, v238
    v_mul_f32 v11, v11, v238
    v_cvt_pk_bf16_f32 v8, v8, v9
    v_cvt_pk_bf16_f32 v9, v10, v11
    v_mfma_f32_16x16x32_bf16 v[204:207], a[144:147], a[32:35], v[204:207]
    v_exp_f32 v196, v196
    ds_write_b64 v230, v[8:9] offset:64
    v_mul_f32 v12, v12, v238
    v_mul_f32 v13, v13, v238
    v_mul_f32 v14, v14, v238
    v_mfma_f32_16x16x32_bf16 v[32:35], a[160:163], v[212:215], v[32:35]
    v_add_f32 v218, v218, v195
    v_cvt_pk_bf16_f32 v209, v194, v195
    v_mul_f32 v15, v15, v238
    v_cvt_pk_bf16_f32 v12, v12, v13
    v_cvt_pk_bf16_f32 v13, v14, v15
    ds_write_b64 v230, v[12:13] offset:96
    v_mfma_f32_16x16x32_bf16 v[36:39], a[164:167], v[212:215], v[36:39]
    v_exp_f32 v197, v197
    v_mul_f32 v16, v16, v238
    v_mul_f32 v17, v17, v238
    v_mul_f32 v18, v18, v238
    v_mul_f32 v19, v19, v238
    v_cvt_pk_bf16_f32 v16, v16, v17
    v_mfma_f32_16x16x32_bf16 v[40:43], a[168:171], v[212:215], v[40:43]
    v_add_f32 v218, v218, v196
    v_cvt_pk_bf16_f32 v17, v18, v19
    ds_write_b64 v230, v[16:17] offset:128
    v_mul_f32 v20, v20, v238
    v_mul_f32 v21, v21, v238
    v_mfma_f32_16x16x32_bf16 v[44:47], a[172:175], v[212:215], v[44:47]
    v_exp_f32 v198, v198
    v_mul_f32 v22, v22, v238
    v_mul_f32 v23, v23, v238
    v_cvt_pk_bf16_f32 v20, v20, v21
    v_cvt_pk_bf16_f32 v21, v22, v23
    ds_write_b64 v230, v[20:21] offset:160
    v_mfma_f32_16x16x32_bf16 v[48:51], a[176:179], v[212:215], v[48:51]
    v_add_f32 v218, v218, v197
    v_cvt_pk_bf16_f32 v210, v196, v197
    v_mul_f32 v24, v24, v238
    v_mul_f32 v25, v25, v238
    v_mul_f32 v26, v26, v238
    v_mul_f32 v27, v27, v238
    v_mfma_f32_16x16x32_bf16 v[52:55], a[180:183], v[212:215], v[52:55]
    v_exp_f32 v199, v199
    v_cvt_pk_bf16_f32 v24, v24, v25
    v_cvt_pk_bf16_f32 v25, v26, v27
    ds_write_b64 v230, v[24:25] offset:192
    v_mul_f32 v28, v28, v238
    v_mul_f32 v29, v29, v238
    v_mfma_f32_16x16x32_bf16 v[56:59], a[184:187], v[212:215], v[56:59]
    v_add_f32 v218, v218, v198
    v_mul_f32 v30, v30, v238
    v_mul_f32 v31, v31, v238
    v_cvt_pk_bf16_f32 v28, v28, v29
    v_cvt_pk_bf16_f32 v29, v30, v31
    v_mfma_f32_16x16x32_bf16 v[60:63], a[188:191], v[212:215], v[60:63]
    v_add_f32 v218, v218, v199
    v_cvt_pk_bf16_f32 v211, v198, v199
    ds_write_b64 v230, v[28:29] offset:224
    ds_read_b128 v[0:3], v231 offset:0
    ds_read_b128 v[4:7], v231 offset:1088
    ds_read_b128 v[8:11], v231 offset:2176
    ds_read_b128 v[12:15], v231 offset:3264
    v_mfma_f32_16x16x32_bf16 v[192:195], a[96:99], a[48:51], 0
    v_exp_f32 v200, v200
    s_waitcnt lgkmcnt(0)
    s_mov_b32 s24, 0
    v_mul_f32 v32, v32, v239
    buffer_store_dwordx4 v[0:3], v227, s[16:19], s24 offen offset:0 sc0 sc1 nt
    v_mfma_f32_16x16x32_bf16 v[192:195], a[100:103], a[52:55], v[192:195]
    v_exp_f32 v201, v201
    v_mul_f32 v33, v33, v239
    v_mul_f32 v34, v34, v239
    v_mul_f32 v35, v35, v239
    v_cvt_pk_bf16_f32 v32, v32, v33
    v_mfma_f32_16x16x32_bf16 v[192:195], a[104:107], a[56:59], v[192:195]
    v_add_f32 v218, v218, v200
    v_cvt_pk_bf16_f32 v33, v34, v35
    ds_write_b64 v230, v[32:33] offset:4352
    v_mul_f32 v36, v36, v239
    v_mfma_f32_16x16x32_bf16 v[248:251], v[252:255], v[0:3], 0
    v_mul_f32 v37, v37, v239
    v_mfma_f32_16x16x32_bf16 v[192:195], a[108:111], a[60:63], v[192:195]
    v_exp_f32 v202, v202
    v_mul_f32 v38, v38, v239
    v_mul_f32 v39, v39, v239
    v_cvt_pk_bf16_f32 v36, v36, v37
    v_cvt_pk_bf16_f32 v37, v38, v39
    v_mfma_f32_16x16x32_bf16 v[196:199], a[124:127], a[60:63], 0
    v_add_f32 v218, v218, v201
    v_cvt_pk_bf16_f32 v212, v200, v201
    ds_write_b64 v230, v[36:37] offset:4384
    v_mul_f32 v40, v40, v239
    v_mul_f32 v41, v41, v239
    buffer_store_dwordx4 v[4:7], v227, s[16:19], s24 offen offset:1024 sc0 sc1 nt
    v_mfma_f32_16x16x32_bf16 v[196:199], a[120:123], a[56:59], v[196:199]
    v_exp_f32 v203, v203
    v_mul_f32 v42, v42, v239
    v_mul_f32 v43, v43, v239
    v_cvt_pk_bf16_f32 v40, v40, v41
    v_cvt_pk_bf16_f32 v41, v42, v43
    ds_write_b64 v230, v[40:41] offset:4416
    v_mfma_f32_16x16x32_bf16 v[196:199], a[116:119], a[52:55], v[196:199]
    v_add_f32 v218, v218, v202
    v_mul_f32 v44, v44, v239
    v_mul_f32 v45, v45, v239
    v_mfma_f32_16x16x32_bf16 v[248:251], v[252:255], v[4:7], v[248:251]
    v_mul_f32 v46, v46, v239
    v_mfma_f32_16x16x32_bf16 v[196:199], a[112:115], a[48:51], v[196:199]
    v_exp_f32 v204, v204
    v_mul_f32 v47, v47, v239
    v_cvt_pk_bf16_f32 v44, v44, v45
    v_cvt_pk_bf16_f32 v45, v46, v47
    ds_write_b64 v230, v[44:45] offset:4448
    v_mul_f32 v48, v48, v239
    v_mfma_f32_16x16x32_bf16 v[64:67], a[224:227], v[208:211], v[64:67]
    v_add_f32 v218, v218, v203
    v_cvt_pk_bf16_f32 v213, v202, v203
    v_mul_f32 v49, v49, v239
    v_mul_f32 v50, v50, v239
    buffer_store_dwordx4 v[8:11], v227, s[16:19], s24 offen offset:2048 sc0 sc1 nt
    v_mul_f32 v51, v51, v239
    v_mfma_f32_16x16x32_bf16 v[68:71], a[228:231], v[208:211], v[68:71]
    v_exp_f32 v205, v205
    v_cvt_pk_bf16_f32 v48, v48, v49
    v_cvt_pk_bf16_f32 v49, v50, v51
    ds_write_b64 v230, v[48:49] offset:4480
    v_mul_f32 v52, v52, v239
    v_mfma_f32_16x16x32_bf16 v[72:75], a[232:235], v[208:211], v[72:75]
    v_add_f32 v218, v218, v204
    v_mul_f32 v53, v53, v239
    v_mul_f32 v54, v54, v239
    v_mfma_f32_16x16x32_bf16 v[248:251], v[252:255], v[8:11], v[248:251]
    v_mul_f32 v55, v55, v239
    v_cvt_pk_bf16_f32 v52, v52, v53
    v_mfma_f32_16x16x32_bf16 v[76:79], a[236:239], v[208:211], v[76:79]
    v_exp_f32 v206, v206
    v_cvt_pk_bf16_f32 v53, v54, v55
    ds_write_b64 v230, v[52:53] offset:4512
    v_mul_f32 v56, v56, v239
    v_mul_f32 v57, v57, v239
    v_mfma_f32_16x16x32_bf16 v[80:83], a[240:243], v[208:211], v[80:83]
    v_add_f32 v218, v218, v205
    v_cvt_pk_bf16_f32 v214, v204, v205
    v_mul_f32 v58, v58, v239
    v_mul_f32 v59, v59, v239
    buffer_store_dwordx4 v[12:15], v227, s[16:19], s24 offen offset:3072 sc0 sc1 nt
    v_cvt_pk_bf16_f32 v56, v56, v57
    v_mfma_f32_16x16x32_bf16 v[84:87], a[244:247], v[208:211], v[84:87]
    v_exp_f32 v207, v207
    v_cvt_pk_bf16_f32 v57, v58, v59
    ds_write_b64 v230, v[56:57] offset:4544
    v_mul_f32 v60, v60, v239
    v_mul_f32 v61, v61, v239
    v_mul_f32 v62, v62, v239
    v_mfma_f32_16x16x32_bf16 v[88:91], a[248:251], v[208:211], v[88:91]
    v_add_f32 v218, v218, v206
    v_mul_f32 v63, v63, v239
    v_mfma_f32_16x16x32_bf16 v[248:251], v[252:255], v[12:15], v[248:251]
    v_cvt_pk_bf16_f32 v60, v60, v61
    v_cvt_pk_bf16_f32 v61, v62, v63
    v_mfma_f32_16x16x32_bf16 v[92:95], a[252:255], v[208:211], v[92:95]
    v_add_f32 v218, v218, v207
    v_cvt_pk_bf16_f32 v215, v206, v207
    ds_write_b64 v230, v[60:61] offset:4576
    ds_read_b128 v[32:35], v231 offset:4352
    ds_read_b128 v[36:39], v231 offset:5440
    ds_read_b128 v[40:43], v231 offset:6528
    ds_read_b128 v[44:47], v231 offset:7616
    v_mfma_f32_16x16x32_bf16 v[200:203], a[128:131], a[48:51], 0
    v_exp_f32 v192, v192
    s_waitcnt lgkmcnt(0)
    v_mfma_f32_16x16x32_bf16 v[200:203], a[132:135], a[52:55], v[200:203]
    v_exp_f32 v193, v193
    s_mov_b32 s24, 4096
    v_mfma_f32_16x16x32_bf16 v[200:203], a[136:139], a[56:59], v[200:203]
    v_add_f32 v219, v219, v192
    v_mov_b32 v234, v218
    v_mfma_f32_16x16x32_bf16 v[200:203], a[140:143], a[60:63], v[200:203]
    v_exp_f32 v194, v194
    buffer_store_dwordx4 v[32:35], v227, s[16:19], s24 offen offset:0 sc0 sc1 nt
    v_mfma_f32_16x16x32_bf16 v[204:207], a[156:159], a[60:63], 0
    v_add_f32 v219, v219, v193
    v_cvt_pk_bf16_f32 v208, v192, v193
    v_mfma_f32_16x16x32_bf16 v[248:251], v[252:255], v[32:35], v[248:251]
    v_mfma_f32_16x16x32_bf16 v[204:207], a[152:155], a[56:59], v[204:207]
    v_exp_f32 v195, v195
    v_permlane32_swap_b32 v218, v234
    v_mfma_f32_16x16x32_bf16 v[204:207], a[148:151], a[52:55], v[204:207]
    v_add_f32 v219, v219, v194
    buffer_store_dwordx4 v[36:39], v227, s[16:19], s24 offen offset:1024 sc0 sc1 nt
    v_mfma_f32_16x16x32_bf16 v[204:207], a[144:147], a[48:51], v[204:207]
    v_exp_f32 v196, v196
    v_add_f32 v218, v218, v234
    v_mfma_f32_16x16x32_bf16 v[64:67], a[160:163], v[212:215], v[64:67]
    v_add_f32 v219, v219, v195
    v_cvt_pk_bf16_f32 v209, v194, v195
    v_mfma_f32_16x16x32_bf16 v[248:251], v[252:255], v[36:39], v[248:251]
    v_mfma_f32_16x16x32_bf16 v[68:71], a[164:167], v[212:215], v[68:71]
    v_exp_f32 v197, v197
    v_mov_b32 v234, v218
    v_mfma_f32_16x16x32_bf16 v[72:75], a[168:171], v[212:215], v[72:75]
    v_add_f32 v219, v219, v196
    buffer_store_dwordx4 v[40:43], v227, s[16:19], s24 offen offset:2048 sc0 sc1 nt
    v_mfma_f32_16x16x32_bf16 v[76:79], a[172:175], v[212:215], v[76:79]
    v_exp_f32 v198, v198
    v_permlane16_swap_b32 v218, v234
    v_mfma_f32_16x16x32_bf16 v[80:83], a[176:179], v[212:215], v[80:83]
    v_add_f32 v219, v219, v197
    v_cvt_pk_bf16_f32 v210, v196, v197
    v_mfma_f32_16x16x32_bf16 v[248:251], v[252:255], v[40:43], v[248:251]
    v_mfma_f32_16x16x32_bf16 v[84:87], a[180:183], v[212:215], v[84:87]
    v_exp_f32 v199, v199
    v_add_f32 v218, v218, v234
    v_mfma_f32_16x16x32_bf16 v[88:91], a[184:187], v[212:215], v[88:91]
    v_add_f32 v219, v219, v198
    buffer_store_dwordx4 v[44:47], v227, s[16:19], s24 offen offset:3072 sc0 sc1 nt
    v_mfma_f32_16x16x32_bf16 v[92:95], a[188:191], v[212:215], v[92:95]
    v_add_f32 v219, v219, v199
    v_cvt_pk_bf16_f32 v211, v198, v199
    v_rcp_f32 v240, v218
    v_mfma_f32_16x16x32_bf16 v[248:251], v[252:255], v[44:47], v[248:251]
    v_mfma_f32_16x16x32_bf16 v[192:195], a[96:99], a[64:67], 0
    v_exp_f32 v200, v200
    v_mul_f32 v64, v64, v240
    v_mul_f32 v65, v65, v240
    v_mul_f32 v66, v66, v240
    v_mfma_f32_16x16x32_bf16 v[192:195], a[100:103], a[68:71], v[192:195]
    v_exp_f32 v201, v201
    v_mul_f32 v67, v67, v240
    v_cvt_pk_bf16_f32 v64, v64, v65
    v_cvt_pk_bf16_f32 v65, v66, v67
    ds_write_b64 v230, v[64:65] offset:0
    v_mfma_f32_16x16x32_bf16 v[192:195], a[104:107], a[72:75], v[192:195]
    v_add_f32 v219, v219, v200
    v_mul_f32 v68, v68, v240
    v_mul_f32 v69, v69, v240
    v_mul_f32 v70, v70, v240
    v_mul_f32 v71, v71, v240
    v_mfma_f32_16x16x32_bf16 v[192:195], a[108:111], a[76:79], v[192:195]
    v_exp_f32 v202, v202
    v_cvt_pk_bf16_f32 v68, v68, v69
    v_cvt_pk_bf16_f32 v69, v70, v71
    ds_write_b64 v230, v[68:69] offset:32
    v_mul_f32 v72, v72, v240
    v_mfma_f32_16x16x32_bf16 v[196:199], a[124:127], a[76:79], 0
    v_add_f32 v219, v219, v201
    v_cvt_pk_bf16_f32 v212, v200, v201
    v_mul_f32 v73, v73, v240
    v_mul_f32 v74, v74, v240
    v_mul_f32 v75, v75, v240
    v_mfma_f32_16x16x32_bf16 v[196:199], a[120:123], a[72:75], v[196:199]
    v_exp_f32 v203, v203
    v_cvt_pk_bf16_f32 v72, v72, v73
    v_cvt_pk_bf16_f32 v73, v74, v75
    ds_write_b64 v230, v[72:73] offset:64
    v_mul_f32 v76, v76, v240
    v_mfma_f32_16x16x32_bf16 v[196:199], a[116:119], a[68:71], v[196:199]
    v_add_f32 v219, v219, v202
    v_mul_f32 v77, v77, v240
    v_mul_f32 v78, v78, v240
    v_mul_f32 v79, v79, v240
    v_cvt_pk_bf16_f32 v76, v76, v77
    v_mfma_f32_16x16x32_bf16 v[196:199], a[112:115], a[64:67], v[196:199]
    v_exp_f32 v204, v204
    v_cvt_pk_bf16_f32 v77, v78, v79
    ds_write_b64 v230, v[76:77] offset:96
    v_mul_f32 v80, v80, v240
    v_mul_f32 v81, v81, v240
    v_mfma_f32_16x16x32_bf16 v[96:99], a[224:227], v[208:211], v[96:99]
    v_add_f32 v219, v219, v203
    v_cvt_pk_bf16_f32 v213, v202, v203
    v_mul_f32 v82, v82, v240
    v_mul_f32 v83, v83, v240
    v_cvt_pk_bf16_f32 v80, v80, v81
    v_mfma_f32_16x16x32_bf16 v[100:103], a[228:231], v[208:211], v[100:103]
    v_exp_f32 v205, v205
    v_cvt_pk_bf16_f32 v81, v82, v83
    ds_write_b64 v230, v[80:81] offset:128
    v_mul_f32 v84, v84, v240
    v_mul_f32 v85, v85, v240
    v_mfma_f32_16x16x32_bf16 v[104:107], a[232:235], v[208:211], v[104:107]
    v_add_f32 v219, v219, v204
    v_mul_f32 v86, v86, v240
    v_mul_f32 v87, v87, v240
    v_cvt_pk_bf16_f32 v84, v84, v85
    v_cvt_pk_bf16_f32 v85, v86, v87
    v_mfma_f32_16x16x32_bf16 v[108:111], a[236:239], v[208:211], v[108:111]
    v_exp_f32 v206, v206
    ds_write_b64 v230, v[84:85] offset:160
    v_mul_f32 v88, v88, v240
    v_mul_f32 v89, v89, v240
    v_mul_f32 v90, v90, v240
    v_mfma_f32_16x16x32_bf16 v[112:115], a[240:243], v[208:211], v[112:115]
    v_add_f32 v219, v219, v205
    v_cvt_pk_bf16_f32 v214, v204, v205
    v_mul_f32 v91, v91, v240
    v_cvt_pk_bf16_f32 v88, v88, v89
    v_cvt_pk_bf16_f32 v89, v90, v91
    v_mfma_f32_16x16x32_bf16 v[116:119], a[244:247], v[208:211], v[116:119]
    v_exp_f32 v207, v207
    ds_write_b64 v230, v[88:89] offset:192
    v_mul_f32 v92, v92, v240
    v_mul_f32 v93, v93, v240
    v_mul_f32 v94, v94, v240
    v_mfma_f32_16x16x32_bf16 v[120:123], a[248:251], v[208:211], v[120:123]
    v_add_f32 v219, v219, v206
    v_mul_f32 v95, v95, v240
    v_cvt_pk_bf16_f32 v92, v92, v93
    v_cvt_pk_bf16_f32 v93, v94, v95
    ds_write_b64 v230, v[92:93] offset:224
    v_mfma_f32_16x16x32_bf16 v[124:127], a[252:255], v[208:211], v[124:127]
    v_add_f32 v219, v219, v207
    v_cvt_pk_bf16_f32 v215, v206, v207
    ds_read_b128 v[64:67], v231 offset:0
    ds_read_b128 v[68:71], v231 offset:1088
    ds_read_b128 v[72:75], v231 offset:2176
    ds_read_b128 v[76:79], v231 offset:3264
    v_mfma_f32_16x16x32_bf16 v[200:203], a[128:131], a[64:67], 0
    v_exp_f32 v192, v192
    s_waitcnt lgkmcnt(0)
    v_mfma_f32_16x16x32_bf16 v[200:203], a[132:135], a[68:71], v[200:203]
    v_exp_f32 v193, v193
    s_mov_b32 s24, 8192
    v_mfma_f32_16x16x32_bf16 v[200:203], a[136:139], a[72:75], v[200:203]
    v_add_f32 v220, v220, v192
    v_mov_b32 v235, v219
    v_mfma_f32_16x16x32_bf16 v[200:203], a[140:143], a[76:79], v[200:203]
    v_exp_f32 v194, v194
    buffer_store_dwordx4 v[64:67], v227, s[16:19], s24 offen offset:0 sc0 sc1 nt
    v_mfma_f32_16x16x32_bf16 v[204:207], a[156:159], a[76:79], 0
    v_add_f32 v220, v220, v193
    v_cvt_pk_bf16_f32 v208, v192, v193
    v_mfma_f32_16x16x32_bf16 v[248:251], v[252:255], v[64:67], v[248:251]
    v_mfma_f32_16x16x32_bf16 v[204:207], a[152:155], a[72:75], v[204:207]
    v_exp_f32 v195, v195
    v_permlane32_swap_b32 v219, v235
    v_mfma_f32_16x16x32_bf16 v[204:207], a[148:151], a[68:71], v[204:207]
    v_add_f32 v220, v220, v194
    buffer_store_dwordx4 v[68:71], v227, s[16:19], s24 offen offset:1024 sc0 sc1 nt
    v_mfma_f32_16x16x32_bf16 v[204:207], a[144:147], a[64:67], v[204:207]
    v_exp_f32 v196, v196
    v_add_f32 v219, v219, v235
    v_mfma_f32_16x16x32_bf16 v[96:99], a[160:163], v[212:215], v[96:99]
    v_add_f32 v220, v220, v195
    v_cvt_pk_bf16_f32 v209, v194, v195
    v_mfma_f32_16x16x32_bf16 v[248:251], v[252:255], v[68:71], v[248:251]
    v_mfma_f32_16x16x32_bf16 v[100:103], a[164:167], v[212:215], v[100:103]
    v_exp_f32 v197, v197
    v_mov_b32 v235, v219
    v_mfma_f32_16x16x32_bf16 v[104:107], a[168:171], v[212:215], v[104:107]
    v_add_f32 v220, v220, v196
    buffer_store_dwordx4 v[72:75], v227, s[16:19], s24 offen offset:2048 sc0 sc1 nt
    v_mfma_f32_16x16x32_bf16 v[108:111], a[172:175], v[212:215], v[108:111]
    v_exp_f32 v198, v198
    v_permlane16_swap_b32 v219, v235
    v_mfma_f32_16x16x32_bf16 v[112:115], a[176:179], v[212:215], v[112:115]
    v_add_f32 v220, v220, v197
    v_cvt_pk_bf16_f32 v210, v196, v197
    v_mfma_f32_16x16x32_bf16 v[248:251], v[252:255], v[72:75], v[248:251]
    v_mfma_f32_16x16x32_bf16 v[116:119], a[180:183], v[212:215], v[116:119]
    v_exp_f32 v199, v199
    v_add_f32 v219, v219, v235
    v_mfma_f32_16x16x32_bf16 v[120:123], a[184:187], v[212:215], v[120:123]
    v_add_f32 v220, v220, v198
    buffer_store_dwordx4 v[76:79], v227, s[16:19], s24 offen offset:3072 sc0 sc1 nt
    v_mfma_f32_16x16x32_bf16 v[124:127], a[188:191], v[212:215], v[124:127]
    v_add_f32 v220, v220, v199
    v_cvt_pk_bf16_f32 v211, v198, v199
    v_rcp_f32 v241, v219
    v_mfma_f32_16x16x32_bf16 v[248:251], v[252:255], v[76:79], v[248:251]
    v_mfma_f32_16x16x32_bf16 v[192:195], a[96:99], a[80:83], 0
    v_exp_f32 v200, v200
    v_mul_f32 v96, v96, v241
    v_mul_f32 v97, v97, v241
    v_mul_f32 v98, v98, v241
    v_mfma_f32_16x16x32_bf16 v[192:195], a[100:103], a[84:87], v[192:195]
    v_exp_f32 v201, v201
    v_mul_f32 v99, v99, v241
    v_cvt_pk_bf16_f32 v96, v96, v97
    v_cvt_pk_bf16_f32 v97, v98, v99
    ds_write_b64 v230, v[96:97] offset:4352
    v_mfma_f32_16x16x32_bf16 v[192:195], a[104:107], a[88:91], v[192:195]
    v_add_f32 v220, v220, v200
    v_mul_f32 v100, v100, v241
    v_mul_f32 v101, v101, v241
    v_mul_f32 v102, v102, v241
    v_mul_f32 v103, v103, v241
    v_mfma_f32_16x16x32_bf16 v[192:195], a[108:111], a[92:95], v[192:195]
    v_exp_f32 v202, v202
    v_cvt_pk_bf16_f32 v100, v100, v101
    v_cvt_pk_bf16_f32 v101, v102, v103
    ds_write_b64 v230, v[100:101] offset:4384
    v_mul_f32 v104, v104, v241
    v_mfma_f32_16x16x32_bf16 v[196:199], a[124:127], a[92:95], 0
    v_add_f32 v220, v220, v201
    v_cvt_pk_bf16_f32 v212, v200, v201
    v_mul_f32 v105, v105, v241
    v_mul_f32 v106, v106, v241
    v_mul_f32 v107, v107, v241
    v_mfma_f32_16x16x32_bf16 v[196:199], a[120:123], a[88:91], v[196:199]
    v_exp_f32 v203, v203
    v_cvt_pk_bf16_f32 v104, v104, v105
    v_cvt_pk_bf16_f32 v105, v106, v107
    ds_write_b64 v230, v[104:105] offset:4416
    v_mul_f32 v108, v108, v241
    v_mfma_f32_16x16x32_bf16 v[196:199], a[116:119], a[84:87], v[196:199]
    v_add_f32 v220, v220, v202
    v_mul_f32 v109, v109, v241
    v_mul_f32 v110, v110, v241
    v_mul_f32 v111, v111, v241
    v_cvt_pk_bf16_f32 v108, v108, v109
    v_mfma_f32_16x16x32_bf16 v[196:199], a[112:115], a[80:83], v[196:199]
    v_exp_f32 v204, v204
    v_cvt_pk_bf16_f32 v109, v110, v111
    ds_write_b64 v230, v[108:109] offset:4448
    v_mul_f32 v112, v112, v241
    v_mul_f32 v113, v113, v241
    v_mfma_f32_16x16x32_bf16 v[128:131], a[224:227], v[208:211], v[128:131]
    v_add_f32 v220, v220, v203
    v_cvt_pk_bf16_f32 v213, v202, v203
    v_mul_f32 v114, v114, v241
    v_mul_f32 v115, v115, v241
    v_cvt_pk_bf16_f32 v112, v112, v113
    v_mfma_f32_16x16x32_bf16 v[132:135], a[228:231], v[208:211], v[132:135]
    v_exp_f32 v205, v205
    v_cvt_pk_bf16_f32 v113, v114, v115
    ds_write_b64 v230, v[112:113] offset:4480
    v_mul_f32 v116, v116, v241
    v_mul_f32 v117, v117, v241
    v_mfma_f32_16x16x32_bf16 v[136:139], a[232:235], v[208:211], v[136:139]
    v_add_f32 v220, v220, v204
    v_mul_f32 v118, v118, v241
    v_mul_f32 v119, v119, v241
    v_cvt_pk_bf16_f32 v116, v116, v117
    v_cvt_pk_bf16_f32 v117, v118, v119
    v_mfma_f32_16x16x32_bf16 v[140:143], a[236:239], v[208:211], v[140:143]
    v_exp_f32 v206, v206
    ds_write_b64 v230, v[116:117] offset:4512
    v_mul_f32 v120, v120, v241
    v_mul_f32 v121, v121, v241
    v_mul_f32 v122, v122, v241
    v_mfma_f32_16x16x32_bf16 v[144:147], a[240:243], v[208:211], v[144:147]
    v_add_f32 v220, v220, v205
    v_cvt_pk_bf16_f32 v214, v204, v205
    v_mul_f32 v123, v123, v241
    v_cvt_pk_bf16_f32 v120, v120, v121
    v_cvt_pk_bf16_f32 v121, v122, v123
    v_mfma_f32_16x16x32_bf16 v[148:151], a[244:247], v[208:211], v[148:151]
    v_exp_f32 v207, v207
    ds_write_b64 v230, v[120:121] offset:4544
    v_mul_f32 v124, v124, v241
    v_mul_f32 v125, v125, v241
    v_mul_f32 v126, v126, v241
    v_mfma_f32_16x16x32_bf16 v[152:155], a[248:251], v[208:211], v[152:155]
    v_add_f32 v220, v220, v206
    v_mul_f32 v127, v127, v241
    v_cvt_pk_bf16_f32 v124, v124, v125
    v_cvt_pk_bf16_f32 v125, v126, v127
    ds_write_b64 v230, v[124:125] offset:4576
    v_mfma_f32_16x16x32_bf16 v[156:159], a[252:255], v[208:211], v[156:159]
    v_add_f32 v220, v220, v207
    v_cvt_pk_bf16_f32 v215, v206, v207
    ds_read_b128 v[96:99], v231 offset:4352
    ds_read_b128 v[100:103], v231 offset:5440
    ds_read_b128 v[104:107], v231 offset:6528
    ds_read_b128 v[108:111], v231 offset:7616
    v_mfma_f32_16x16x32_bf16 v[200:203], a[128:131], a[80:83], 0
    v_exp_f32 v192, v192
    s_waitcnt lgkmcnt(0)
    v_mfma_f32_16x16x32_bf16 v[200:203], a[132:135], a[84:87], v[200:203]
    v_exp_f32 v193, v193
    s_mov_b32 s24, 12288
    v_mfma_f32_16x16x32_bf16 v[200:203], a[136:139], a[88:91], v[200:203]
    v_add_f32 v221, v221, v192
    v_mov_b32 v236, v220
    v_mfma_f32_16x16x32_bf16 v[200:203], a[140:143], a[92:95], v[200:203]
    v_exp_f32 v194, v194
    buffer_store_dwordx4 v[96:99], v227, s[16:19], s24 offen offset:0 sc0 sc1 nt
    v_mfma_f32_16x16x32_bf16 v[204:207], a[156:159], a[92:95], 0
    v_add_f32 v221, v221, v193
    v_cvt_pk_bf16_f32 v208, v192, v193
    v_mfma_f32_16x16x32_bf16 v[248:251], v[252:255], v[96:99], v[248:251]
    v_mfma_f32_16x16x32_bf16 v[204:207], a[152:155], a[88:91], v[204:207]
    v_exp_f32 v195, v195
    v_permlane32_swap_b32 v220, v236
    v_mfma_f32_16x16x32_bf16 v[204:207], a[148:151], a[84:87], v[204:207]
    v_add_f32 v221, v221, v194
    buffer_store_dwordx4 v[100:103], v227, s[16:19], s24 offen offset:1024 sc0 sc1 nt
    v_mfma_f32_16x16x32_bf16 v[204:207], a[144:147], a[80:83], v[204:207]
    v_exp_f32 v196, v196
    v_add_f32 v220, v220, v236
    v_mfma_f32_16x16x32_bf16 v[128:131], a[160:163], v[212:215], v[128:131]
    v_add_f32 v221, v221, v195
    v_cvt_pk_bf16_f32 v209, v194, v195
    v_mfma_f32_16x16x32_bf16 v[248:251], v[252:255], v[100:103], v[248:251]
    v_mfma_f32_16x16x32_bf16 v[132:135], a[164:167], v[212:215], v[132:135]
    v_exp_f32 v197, v197
    v_mov_b32 v236, v220
    v_mfma_f32_16x16x32_bf16 v[136:139], a[168:171], v[212:215], v[136:139]
    v_add_f32 v221, v221, v196
    buffer_store_dwordx4 v[104:107], v227, s[16:19], s24 offen offset:2048 sc0 sc1 nt
    v_mfma_f32_16x16x32_bf16 v[140:143], a[172:175], v[212:215], v[140:143]
    v_exp_f32 v198, v198
    v_permlane16_swap_b32 v220, v236
    v_mfma_f32_16x16x32_bf16 v[144:147], a[176:179], v[212:215], v[144:147]
    v_add_f32 v221, v221, v197
    v_cvt_pk_bf16_f32 v210, v196, v197
    v_mfma_f32_16x16x32_bf16 v[248:251], v[252:255], v[104:107], v[248:251]
    v_mfma_f32_16x16x32_bf16 v[148:151], a[180:183], v[212:215], v[148:151]
    v_exp_f32 v199, v199
    v_add_f32 v220, v220, v236
    v_mfma_f32_16x16x32_bf16 v[152:155], a[184:187], v[212:215], v[152:155]
    v_add_f32 v221, v221, v198
    buffer_store_dwordx4 v[108:111], v227, s[16:19], s24 offen offset:3072 sc0 sc1 nt
    v_mfma_f32_16x16x32_bf16 v[156:159], a[188:191], v[212:215], v[156:159]
    v_add_f32 v221, v221, v199
    v_cvt_pk_bf16_f32 v211, v198, v199
    v_rcp_f32 v242, v220
    v_mfma_f32_16x16x32_bf16 v[248:251], v[252:255], v[108:111], v[248:251]
    v_exp_f32 v200, v200
    v_mul_f32 v128, v128, v242
    v_mul_f32 v129, v129, v242
    v_mul_f32 v130, v130, v242
    v_exp_f32 v201, v201
    v_mul_f32 v131, v131, v242
    v_cvt_pk_bf16_f32 v128, v128, v129
    v_cvt_pk_bf16_f32 v129, v130, v131
    ds_write_b64 v230, v[128:129] offset:0
    v_add_f32 v221, v221, v200
    v_mul_f32 v132, v132, v242
    v_mul_f32 v133, v133, v242
    v_mul_f32 v134, v134, v242
    v_mul_f32 v135, v135, v242
    v_exp_f32 v202, v202
    v_cvt_pk_bf16_f32 v132, v132, v133
    v_cvt_pk_bf16_f32 v133, v134, v135
    ds_write_b64 v230, v[132:133] offset:32
    v_mul_f32 v136, v136, v242
    v_add_f32 v221, v221, v201
    v_cvt_pk_bf16_f32 v212, v200, v201
    v_mul_f32 v137, v137, v242
    v_mul_f32 v138, v138, v242
    v_mul_f32 v139, v139, v242
    v_exp_f32 v203, v203
    v_cvt_pk_bf16_f32 v136, v136, v137
    v_cvt_pk_bf16_f32 v137, v138, v139
    ds_write_b64 v230, v[136:137] offset:64
    v_mul_f32 v140, v140, v242
    v_add_f32 v221, v221, v202
    v_mul_f32 v141, v141, v242
    v_mul_f32 v142, v142, v242
    v_mul_f32 v143, v143, v242
    v_cvt_pk_bf16_f32 v140, v140, v141
    v_exp_f32 v204, v204
    v_cvt_pk_bf16_f32 v141, v142, v143
    ds_write_b64 v230, v[140:141] offset:96
    v_mul_f32 v144, v144, v242
    v_mul_f32 v145, v145, v242
    v_mfma_f32_16x16x32_bf16 v[160:163], a[224:227], v[208:211], v[160:163]
    v_add_f32 v221, v221, v203
    v_cvt_pk_bf16_f32 v213, v202, v203
    v_mul_f32 v146, v146, v242
    v_mul_f32 v147, v147, v242
    v_cvt_pk_bf16_f32 v144, v144, v145
    v_mfma_f32_16x16x32_bf16 v[164:167], a[228:231], v[208:211], v[164:167]
    v_exp_f32 v205, v205
    v_cvt_pk_bf16_f32 v145, v146, v147
    ds_write_b64 v230, v[144:145] offset:128
    v_mul_f32 v148, v148, v242
    v_mul_f32 v149, v149, v242
    v_mfma_f32_16x16x32_bf16 v[168:171], a[232:235], v[208:211], v[168:171]
    v_add_f32 v221, v221, v204
    v_mul_f32 v150, v150, v242
    v_mul_f32 v151, v151, v242
    v_cvt_pk_bf16_f32 v148, v148, v149
    v_cvt_pk_bf16_f32 v149, v150, v151
    v_mfma_f32_16x16x32_bf16 v[172:175], a[236:239], v[208:211], v[172:175]
    v_exp_f32 v206, v206
    ds_write_b64 v230, v[148:149] offset:160
    v_mul_f32 v152, v152, v242
    v_mul_f32 v153, v153, v242
    v_mul_f32 v154, v154, v242
    v_mfma_f32_16x16x32_bf16 v[176:179], a[240:243], v[208:211], v[176:179]
    v_add_f32 v221, v221, v205
    v_cvt_pk_bf16_f32 v214, v204, v205
    v_mul_f32 v155, v155, v242
    v_cvt_pk_bf16_f32 v152, v152, v153
    v_cvt_pk_bf16_f32 v153, v154, v155
    v_mfma_f32_16x16x32_bf16 v[180:183], a[244:247], v[208:211], v[180:183]
    v_exp_f32 v207, v207
    ds_write_b64 v230, v[152:153] offset:192
    v_mul_f32 v156, v156, v242
    v_mul_f32 v157, v157, v242
    v_mul_f32 v158, v158, v242
    v_mfma_f32_16x16x32_bf16 v[184:187], a[248:251], v[208:211], v[184:187]
    v_add_f32 v221, v221, v206
    v_mul_f32 v159, v159, v242
    v_cvt_pk_bf16_f32 v156, v156, v157
    v_cvt_pk_bf16_f32 v157, v158, v159
    ds_write_b64 v230, v[156:157] offset:224
    v_mfma_f32_16x16x32_bf16 v[188:191], a[252:255], v[208:211], v[188:191]
    v_add_f32 v221, v221, v207
    v_cvt_pk_bf16_f32 v215, v206, v207
    ds_read_b128 v[128:131], v231 offset:0
    ds_read_b128 v[132:135], v231 offset:1088
    ds_read_b128 v[136:139], v231 offset:2176
    ds_read_b128 v[140:143], v231 offset:3264
    s_nop 1
    v_mfma_f32_16x16x32_bf16 v[160:163], a[160:163], v[212:215], v[160:163]
    s_waitcnt lgkmcnt(0)
    s_mov_b32 s24, 16384
    v_mfma_f32_16x16x32_bf16 v[164:167], a[164:167], v[212:215], v[164:167]
    v_mov_b32 v237, v221
    buffer_store_dwordx4 v[128:131], v227, s[16:19], s24 offen offset:0 sc0 sc1 nt
    v_mfma_f32_16x16x32_bf16 v[168:171], a[168:171], v[212:215], v[168:171]
    v_mfma_f32_16x16x32_bf16 v[248:251], v[252:255], v[128:131], v[248:251]
    v_permlane32_swap_b32 v221, v237
    v_mfma_f32_16x16x32_bf16 v[172:175], a[172:175], v[212:215], v[172:175]
    buffer_store_dwordx4 v[132:135], v227, s[16:19], s24 offen offset:1024 sc0 sc1 nt
    v_add_f32 v221, v221, v237
    v_mfma_f32_16x16x32_bf16 v[176:179], a[176:179], v[212:215], v[176:179]
    v_mfma_f32_16x16x32_bf16 v[248:251], v[252:255], v[132:135], v[248:251]
    v_mov_b32 v237, v221
    v_mfma_f32_16x16x32_bf16 v[180:183], a[180:183], v[212:215], v[180:183]
    buffer_store_dwordx4 v[136:139], v227, s[16:19], s24 offen offset:2048 sc0 sc1 nt
    v_permlane16_swap_b32 v221, v237
    v_mfma_f32_16x16x32_bf16 v[184:187], a[184:187], v[212:215], v[184:187]
    v_mfma_f32_16x16x32_bf16 v[248:251], v[252:255], v[136:139], v[248:251]
    v_add_f32 v221, v221, v237
    v_mfma_f32_16x16x32_bf16 v[188:191], a[188:191], v[212:215], v[188:191]
    buffer_store_dwordx4 v[140:143], v227, s[16:19], s24 offen offset:3072 sc0 sc1 nt
    v_rcp_f32 v243, v221
    v_mfma_f32_16x16x32_bf16 v[248:251], v[252:255], v[140:143], v[248:251]
    v_mov_b32 v228, v243
    v_mov_b32 v229, v243
    v_pk_mul_f32 v[160:161], v[160:161], v[228:229]
    v_pk_mul_f32 v[162:163], v[162:163], v[228:229]
    v_cvt_pk_bf16_f32 v160, v160, v161
    v_cvt_pk_bf16_f32 v161, v162, v163
    ds_write_b64 v230, v[160:161] offset:4352
    v_pk_mul_f32 v[164:165], v[164:165], v[228:229]
    v_pk_mul_f32 v[166:167], v[166:167], v[228:229]
    v_cvt_pk_bf16_f32 v164, v164, v165
    v_cvt_pk_bf16_f32 v165, v166, v167
    ds_write_b64 v230, v[164:165] offset:4384
    v_pk_mul_f32 v[168:169], v[168:169], v[228:229]
    v_pk_mul_f32 v[170:171], v[170:171], v[228:229]
    v_cvt_pk_bf16_f32 v168, v168, v169
    v_cvt_pk_bf16_f32 v169, v170, v171
    ds_write_b64 v230, v[168:169] offset:4416
    v_pk_mul_f32 v[172:173], v[172:173], v[228:229]
    v_pk_mul_f32 v[174:175], v[174:175], v[228:229]
    v_cvt_pk_bf16_f32 v172, v172, v173
    v_cvt_pk_bf16_f32 v173, v174, v175
    ds_write_b64 v230, v[172:173] offset:4448
    v_pk_mul_f32 v[176:177], v[176:177], v[228:229]
    v_pk_mul_f32 v[178:179], v[178:179], v[228:229]
    v_cvt_pk_bf16_f32 v176, v176, v177
    v_cvt_pk_bf16_f32 v177, v178, v179
    ds_write_b64 v230, v[176:177] offset:4480
    v_pk_mul_f32 v[180:181], v[180:181], v[228:229]
    v_pk_mul_f32 v[182:183], v[182:183], v[228:229]
    v_cvt_pk_bf16_f32 v180, v180, v181
    v_cvt_pk_bf16_f32 v181, v182, v183
    ds_write_b64 v230, v[180:181] offset:4512
    v_pk_mul_f32 v[184:185], v[184:185], v[228:229]
    v_pk_mul_f32 v[186:187], v[186:187], v[228:229]
    v_cvt_pk_bf16_f32 v184, v184, v185
    v_cvt_pk_bf16_f32 v185, v186, v187
    ds_write_b64 v230, v[184:185] offset:4544
    v_pk_mul_f32 v[188:189], v[188:189], v[228:229]
    v_pk_mul_f32 v[190:191], v[190:191], v[228:229]
    v_cvt_pk_bf16_f32 v188, v188, v189
    v_cvt_pk_bf16_f32 v189, v190, v191
    ds_write_b64 v230, v[188:189] offset:4576
    ds_read_b128 v[160:163], v231 offset:4352
    ds_read_b128 v[164:167], v231 offset:5440
    ds_read_b128 v[168:171], v231 offset:6528
    ds_read_b128 v[172:175], v231 offset:7616
    s_waitcnt lgkmcnt(0)
    s_mov_b32 s24, 20480
    buffer_store_dwordx4 v[160:163], v227, s[16:19], s24 offen offset:0 sc0 sc1 nt
    v_mfma_f32_16x16x32_bf16 v[248:251], v[252:255], v[160:163], v[248:251]
    buffer_store_dwordx4 v[164:167], v227, s[16:19], s24 offen offset:1024 sc0 sc1 nt
    v_mfma_f32_16x16x32_bf16 v[248:251], v[252:255], v[164:167], v[248:251]
    buffer_store_dwordx4 v[168:171], v227, s[16:19], s24 offen offset:2048 sc0 sc1 nt
    v_mfma_f32_16x16x32_bf16 v[248:251], v[252:255], v[168:171], v[248:251]
    buffer_store_dwordx4 v[172:175], v227, s[16:19], s24 offen offset:3072 sc0 sc1 nt
    v_mfma_f32_16x16x32_bf16 v[248:251], v[252:255], v[172:175], v[248:251]
    v_max3_f32 v232, v216, v217, v218
    v_min3_f32 v233, v216, v217, v218
    v_max3_f32 v232, v232, v219, v220
    v_min3_f32 v233, v233, v219, v220
    v_max_f32 v232, v232, v221
    v_min_f32 v233, v233, v221
    s_mov_b32 s25, 0x53800000
    s_mov_b32 s27, 0x3d800000
    v_cmp_ge_f32 vcc, s25, v232
    v_cmp_le_f32 s[90:91], s27, v233
    s_and_b64 vcc, vcc, s[90:91]
    v_add_f32 v248, v248, v249
    v_add_f32 v250, v250, v251
    v_add_f32 v248, v248, v250
    v_cmp_o_f32 s[90:91], v248, v248
    s_and_b64 vcc, vcc, s[90:91]
    s_cmp_eq_u64 vcc, -1
    s_cbranch_scc0 L_fallback
L_end:
    s_endpgm
L_fallback:
    s_waitcnt vmcnt(0) lgkmcnt(0)
    s_barrier
    s_lshl_b32 s24, s20, 11
    v_subrev_u32 v228, s24, v224
    v_subrev_u32 v229, s24, v225
    s_mul_i32 s21, s20, 16896
    v_add_u32 v230, s21, v222
    v_add_u32 v231, s21, v223
    v_mov_b32 v216, 0xff800000
    v_mov_b32 v217, 0xff800000
    v_mov_b32 v218, 0xff800000
    v_mov_b32 v219, 0xff800000
    v_mov_b32 v220, 0xff800000
    v_mov_b32 v221, 0xff800000
    s_mov_b32 s25, 0
L_fb1:
    s_add_u32 m0, s21, 0
    s_add_u32 s22, s25, 0
    buffer_load_dwordx4 v228, s[8:11], s22 offen nt lds
    buffer_load_dwordx4 v229, s[8:11], s22 offen offset:1056 nt lds
    s_add_u32 m0, s21, 4224
    s_add_u32 s22, s25, 2048
    buffer_load_dwordx4 v228, s[8:11], s22 offen nt lds
    buffer_load_dwordx4 v229, s[8:11], s22 offen offset:1056 nt lds
    s_add_u32 m0, s21, 8448
    s_add_u32 s22, s25, 4096
    buffer_load_dwordx4 v228, s[8:11], s22 offen nt lds
    buffer_load_dwordx4 v229, s[8:11], s22 offen offset:1056 nt lds
    s_add_u32 m0, s21, 12672
    s_add_u32 s22, s25, 6144
    buffer_load_dwordx4 v228, s[8:11], s22 offen nt lds
    buffer_load_dwordx4 v229, s[8:11], s22 offen offset:1056 nt lds
    s_waitcnt vmcnt(0)
    ds_read_b128 a[96:99], v230 offset:0
    ds_read_b128 a[100:103], v230 offset:256
    ds_read_b128 a[104:107], v230 offset:512
    ds_read_b128 a[108:111], v230 offset:768
    ds_read_b128 a[112:115], v230 offset:8448
    ds_read_b128 a[116:119], v230 offset:8704
    ds_read_b128 a[120:123], v230 offset:8960
    ds_read_b128 a[124:127], v230 offset:9216
    s_waitcnt lgkmcnt(0)
    v_mfma_f32_16x16x32_bf16 v[192:195], a[96:99], a[0:3], 0
    v_mfma_f32_16x16x32_bf16 v[192:195], a[100:103], a[4:7], v[192:195]
    v_mfma_f32_16x16x32_bf16 v[192:195], a[104:107], a[8:11], v[192:195]
    v_mfma_f32_16x16x32_bf16 v[192:195], a[108:111], a[12:15], v[192:195]
    v_mfma_f32_16x16x32_bf16 v[196:199], a[124:127], a[12:15], 0
    v_mfma_f32_16x16x32_bf16 v[196:199], a[120:123], a[8:11], v[196:199]
    v_mfma_f32_16x16x32_bf16 v[196:199], a[116:119], a[4:7], v[196:199]
    v_mfma_f32_16x16x32_bf16 v[196:199], a[112:115], a[0:3], v[196:199]
    s_nop 7
    s_nop 1
    v_max3_f32 v216, v216, v192, v193
    v_max3_f32 v216, v216, v194, v195
    v_max3_f32 v216, v216, v196, v197
    v_max3_f32 v216, v216, v198, v199
    v_mfma_f32_16x16x32_bf16 v[200:203], a[96:99], a[16:19], 0
    v_mfma_f32_16x16x32_bf16 v[200:203], a[100:103], a[20:23], v[200:203]
    v_mfma_f32_16x16x32_bf16 v[200:203], a[104:107], a[24:27], v[200:203]
    v_mfma_f32_16x16x32_bf16 v[200:203], a[108:111], a[28:31], v[200:203]
    v_mfma_f32_16x16x32_bf16 v[204:207], a[124:127], a[28:31], 0
    v_mfma_f32_16x16x32_bf16 v[204:207], a[120:123], a[24:27], v[204:207]
    v_mfma_f32_16x16x32_bf16 v[204:207], a[116:119], a[20:23], v[204:207]
    v_mfma_f32_16x16x32_bf16 v[204:207], a[112:115], a[16:19], v[204:207]
    s_nop 7
    s_nop 1
    v_max3_f32 v217, v217, v200, v201
    v_max3_f32 v217, v217, v202, v203
    v_max3_f32 v217, v217, v204, v205
    v_max3_f32 v217, v217, v206, v207
    v_mfma_f32_16x16x32_bf16 v[192:195], a[96:99], a[32:35], 0
    v_mfma_f32_16x16x32_bf16 v[192:195], a[100:103], a[36:39], v[192:195]
    v_mfma_f32_16x16x32_bf16 v[192:195], a[104:107], a[40:43], v[192:195]
    v_mfma_f32_16x16x32_bf16 v[192:195], a[108:111], a[44:47], v[192:195]
    v_mfma_f32_16x16x32_bf16 v[196:199], a[124:127], a[44:47], 0
    v_mfma_f32_16x16x32_bf16 v[196:199], a[120:123], a[40:43], v[196:199]
    v_mfma_f32_16x16x32_bf16 v[196:199], a[116:119], a[36:39], v[196:199]
    v_mfma_f32_16x16x32_bf16 v[196:199], a[112:115], a[32:35], v[196:199]
    s_nop 7
    s_nop 1
    v_max3_f32 v218, v218, v192, v193
    v_max3_f32 v218, v218, v194, v195
    v_max3_f32 v218, v218, v196, v197
    v_max3_f32 v218, v218, v198, v199
    v_mfma_f32_16x16x32_bf16 v[200:203], a[96:99], a[48:51], 0
    v_mfma_f32_16x16x32_bf16 v[200:203], a[100:103], a[52:55], v[200:203]
    v_mfma_f32_16x16x32_bf16 v[200:203], a[104:107], a[56:59], v[200:203]
    v_mfma_f32_16x16x32_bf16 v[200:203], a[108:111], a[60:63], v[200:203]
    v_mfma_f32_16x16x32_bf16 v[204:207], a[124:127], a[60:63], 0
    v_mfma_f32_16x16x32_bf16 v[204:207], a[120:123], a[56:59], v[204:207]
    v_mfma_f32_16x16x32_bf16 v[204:207], a[116:119], a[52:55], v[204:207]
    v_mfma_f32_16x16x32_bf16 v[204:207], a[112:115], a[48:51], v[204:207]
    s_nop 7
    s_nop 1
    v_max3_f32 v219, v219, v200, v201
    v_max3_f32 v219, v219, v202, v203
    v_max3_f32 v219, v219, v204, v205
    v_max3_f32 v219, v219, v206, v207
    v_mfma_f32_16x16x32_bf16 v[192:195], a[96:99], a[64:67], 0
    v_mfma_f32_16x16x32_bf16 v[192:195], a[100:103], a[68:71], v[192:195]
    v_mfma_f32_16x16x32_bf16 v[192:195], a[104:107], a[72:75], v[192:195]
    v_mfma_f32_16x16x32_bf16 v[192:195], a[108:111], a[76:79], v[192:195]
    v_mfma_f32_16x16x32_bf16 v[196:199], a[124:127], a[76:79], 0
    v_mfma_f32_16x16x32_bf16 v[196:199], a[120:123], a[72:75], v[196:199]
    v_mfma_f32_16x16x32_bf16 v[196:199], a[116:119], a[68:71], v[196:199]
    v_mfma_f32_16x16x32_bf16 v[196:199], a[112:115], a[64:67], v[196:199]
    s_nop 7
    s_nop 1
    v_max3_f32 v220, v220, v192, v193
    v_max3_f32 v220, v220, v194, v195
    v_max3_f32 v220, v220, v196, v197
    v_max3_f32 v220, v220, v198, v199
    v_mfma_f32_16x16x32_bf16 v[200:203], a[96:99], a[80:83], 0
    v_mfma_f32_16x16x32_bf16 v[200:203], a[100:103], a[84:87], v[200:203]
    v_mfma_f32_16x16x32_bf16 v[200:203], a[104:107], a[88:91], v[200:203]
    v_mfma_f32_16x16x32_bf16 v[200:203], a[108:111], a[92:95], v[200:203]
    v_mfma_f32_16x16x32_bf16 v[204:207], a[124:127], a[92:95], 0
    v_mfma_f32_16x16x32_bf16 v[204:207], a[120:123], a[88:91], v[204:207]
    v_mfma_f32_16x16x32_bf16 v[204:207], a[116:119], a[84:87], v[204:207]
    v_mfma_f32_16x16x32_bf16 v[204:207], a[112:115], a[80:83], v[204:207]
    s_nop 7
    s_nop 1
    v_max3_f32 v221, v221, v200, v201
    v_max3_f32 v221, v221, v202, v203
    v_max3_f32 v221, v221, v204, v205
    v_max3_f32 v221, v221, v206, v207
    s_add_u32 s25, s25, 8192
    s_cmp_lt_u32 s25, 524288
    s_cbranch_scc1 L_fb1
    v_mov_b32 v232, v216
    s_nop 1
    v_mov_b32 v233, v217
    s_nop 1
    v_mov_b32 v234, v218
    s_nop 1
    v_mov_b32 v235, v219
    s_nop 1
    v_mov_b32 v236, v220
    s_nop 1
    v_mov_b32 v237, v221
    s_nop 1
    v_permlane32_swap_b32 v216, v232
    s_nop 1
    v_permlane32_swap_b32 v217, v233
    s_nop 1
    v_permlane32_swap_b32 v218, v234
    s_nop 1
    v_permlane32_swap_b32 v219, v235
    s_nop 1
    v_permlane32_swap_b32 v220, v236
    s_nop 1
    v_permlane32_swap_b32 v221, v237
    s_nop 1
    v_max_f32 v216, v216, v232
    s_nop 1
    v_max_f32 v217, v217, v233
    s_nop 1
    v_max_f32 v218, v218, v234
    s_nop 1
    v_max_f32 v219, v219, v235
    s_nop 1
    v_max_f32 v220, v220, v236
    s_nop 1
    v_max_f32 v221, v221, v237
    s_nop 1
    v_mov_b32 v232, v216
    s_nop 1
    v_mov_b32 v233, v217
    s_nop 1
    v_mov_b32 v234, v218
    s_nop 1
    v_mov_b32 v235, v219
    s_nop 1
    v_mov_b32 v236, v220
    s_nop 1
    v_mov_b32 v237, v221
    s_nop 1
    v_permlane16_swap_b32 v216, v232
    s_nop 1
    v_permlane16_swap_b32 v217, v233
    s_nop 1
    v_permlane16_swap_b32 v218, v234
    s_nop 1
    v_permlane16_swap_b32 v219, v235
    s_nop 1
    v_permlane16_swap_b32 v220, v236
    s_nop 1
    v_permlane16_swap_b32 v221, v237
    s_nop 1
    v_max_f32 v216, v216, v232
    s_nop 1
    v_max_f32 v217, v217, v233
    s_nop 1
    v_max_f32 v218, v218, v234
    s_nop 1
    v_max_f32 v219, v219, v235
    s_nop 1
    v_max_f32 v220, v220, v236
    s_nop 1
    v_max_f32 v221, v221, v237
    s_nop 1
    v_sub_f32 v232, 0, v216
    v_sub_f32 v233, 0, v216
    v_sub_f32 v234, 0, v216
    v_sub_f32 v235, 0, v216
    v_sub_f32 v236, 0, v217
    v_sub_f32 v237, 0, v217
    v_sub_f32 v238, 0, v217
    v_sub_f32 v239, 0, v217
    v_sub_f32 v240, 0, v218
    v_sub_f32 v241, 0, v218
    v_sub_f32 v242, 0, v218
    v_sub_f32 v243, 0, v218
    v_sub_f32 v244, 0, v219
    v_sub_f32 v245, 0, v219
    v_sub_f32 v246, 0, v219
    v_sub_f32 v247, 0, v219
    v_sub_f32 v248, 0, v220
    v_sub_f32 v249, 0, v220
    v_sub_f32 v250, 0, v220
    v_sub_f32 v251, 0, v220
    v_sub_f32 v252, 0, v221
    v_sub_f32 v253, 0, v221
    v_sub_f32 v254, 0, v221
    v_sub_f32 v255, 0, v221
    v_mov_b32 v216, 0
    v_mov_b32 v217, 0
    v_mov_b32 v218, 0
    v_mov_b32 v219, 0
    v_mov_b32 v220, 0
    v_mov_b32 v221, 0
    v_mov_b32 v0, 0
    v_mov_b32 v1, 0
    v_mov_b32 v2, 0
    v_mov_b32 v3, 0
    v_mov_b32 v4, 0
    v_mov_b32 v5, 0
    v_mov_b32 v6, 0
    v_mov_b32 v7, 0
    v_mov_b32 v8, 0
    v_mov_b32 v9, 0
    v_mov_b32 v10, 0
    v_mov_b32 v11, 0
    v_mov_b32 v12, 0
    v_mov_b32 v13, 0
    v_mov_b32 v14, 0
    v_mov_b32 v15, 0
    v_mov_b32 v16, 0
    v_mov_b32 v17, 0
    v_mov_b32 v18, 0
    v_mov_b32 v19, 0
    v_mov_b32 v20, 0
    v_mov_b32 v21, 0
    v_mov_b32 v22, 0
    v_mov_b32 v23, 0
    v_mov_b32 v24, 0
    v_mov_b32 v25, 0
    v_mov_b32 v26, 0
    v_mov_b32 v27, 0
    v_mov_b32 v28, 0
    v_mov_b32 v29, 0
    v_mov_b32 v30, 0
    v_mov_b32 v31, 0
    v_mov_b32 v32, 0
    v_mov_b32 v33, 0
    v_mov_b32 v34, 0
    v_mov_b32 v35, 0
    v_mov_b32 v36, 0
    v_mov_b32 v37, 0
    v_mov_b32 v38, 0
    v_mov_b32 v39, 0
    v_mov_b32 v40, 0
    v_mov_b32 v41, 0
    v_mov_b32 v42, 0
    v_mov_b32 v43, 0
    v_mov_b32 v44, 0
    v_mov_b32 v45, 0
    v_mov_b32 v46, 0
    v_mov_b32 v47, 0
    v_mov_b32 v48, 0
    v_mov_b32 v49, 0
    v_mov_b32 v50, 0
    v_mov_b32 v51, 0
    v_mov_b32 v52, 0
    v_mov_b32 v53, 0
    v_mov_b32 v54, 0
    v_mov_b32 v55, 0
    v_mov_b32 v56, 0
    v_mov_b32 v57, 0
    v_mov_b32 v58, 0
    v_mov_b32 v59, 0
    v_mov_b32 v60, 0
    v_mov_b32 v61, 0
    v_mov_b32 v62, 0
    v_mov_b32 v63, 0
    v_mov_b32 v64, 0
    v_mov_b32 v65, 0
    v_mov_b32 v66, 0
    v_mov_b32 v67, 0
    v_mov_b32 v68, 0
    v_mov_b32 v69, 0
    v_mov_b32 v70, 0
    v_mov_b32 v71, 0
    v_mov_b32 v72, 0
    v_mov_b32 v73, 0
    v_mov_b32 v74, 0
    v_mov_b32 v75, 0
    v_mov_b32 v76, 0
    v_mov_b32 v77, 0
    v_mov_b32 v78, 0
    v_mov_b32 v79, 0
    v_mov_b32 v80, 0
    v_mov_b32 v81, 0
    v_mov_b32 v82, 0
    v_mov_b32 v83, 0
    v_mov_b32 v84, 0
    v_mov_b32 v85, 0
    v_mov_b32 v86, 0
    v_mov_b32 v87, 0
    v_mov_b32 v88, 0
    v_mov_b32 v89, 0
    v_mov_b32 v90, 0
    v_mov_b32 v91, 0
    v_mov_b32 v92, 0
    v_mov_b32 v93, 0
    v_mov_b32 v94, 0
    v_mov_b32 v95, 0
    v_mov_b32 v96, 0
    v_mov_b32 v97, 0
    v_mov_b32 v98, 0
    v_mov_b32 v99, 0
    v_mov_b32 v100, 0
    v_mov_b32 v101, 0
    v_mov_b32 v102, 0
    v_mov_b32 v103, 0
    v_mov_b32 v104, 0
    v_mov_b32 v105, 0
    v_mov_b32 v106, 0
    v_mov_b32 v107, 0
    v_mov_b32 v108, 0
    v_mov_b32 v109, 0
    v_mov_b32 v110, 0
    v_mov_b32 v111, 0
    v_mov_b32 v112, 0
    v_mov_b32 v113, 0
    v_mov_b32 v114, 0
    v_mov_b32 v115, 0
    v_mov_b32 v116, 0
    v_mov_b32 v117, 0
    v_mov_b32 v118, 0
    v_mov_b32 v119, 0
    v_mov_b32 v120, 0
    v_mov_b32 v121, 0
    v_mov_b32 v122, 0
    v_mov_b32 v123, 0
    v_mov_b32 v124, 0
    v_mov_b32 v125, 0
    v_mov_b32 v126, 0
    v_mov_b32 v127, 0
    v_mov_b32 v128, 0
    v_mov_b32 v129, 0
    v_mov_b32 v130, 0
    v_mov_b32 v131, 0
    v_mov_b32 v132, 0
    v_mov_b32 v133, 0
    v_mov_b32 v134, 0
    v_mov_b32 v135, 0
    v_mov_b32 v136, 0
    v_mov_b32 v137, 0
    v_mov_b32 v138, 0
    v_mov_b32 v139, 0
    v_mov_b32 v140, 0
    v_mov_b32 v141, 0
    v_mov_b32 v142, 0
    v_mov_b32 v143, 0
    v_mov_b32 v144, 0
    v_mov_b32 v145, 0
    v_mov_b32 v146, 0
    v_mov_b32 v147, 0
    v_mov_b32 v148, 0
    v_mov_b32 v149, 0
    v_mov_b32 v150, 0
    v_mov_b32 v151, 0
    v_mov_b32 v152, 0
    v_mov_b32 v153, 0
    v_mov_b32 v154, 0
    v_mov_b32 v155, 0
    v_mov_b32 v156, 0
    v_mov_b32 v157, 0
    v_mov_b32 v158, 0
    v_mov_b32 v159, 0
    v_mov_b32 v160, 0
    v_mov_b32 v161, 0
    v_mov_b32 v162, 0
    v_mov_b32 v163, 0
    v_mov_b32 v164, 0
    v_mov_b32 v165, 0
    v_mov_b32 v166, 0
    v_mov_b32 v167, 0
    v_mov_b32 v168, 0
    v_mov_b32 v169, 0
    v_mov_b32 v170, 0
    v_mov_b32 v171, 0
    v_mov_b32 v172, 0
    v_mov_b32 v173, 0
    v_mov_b32 v174, 0
    v_mov_b32 v175, 0
    v_mov_b32 v176, 0
    v_mov_b32 v177, 0
    v_mov_b32 v178, 0
    v_mov_b32 v179, 0
    v_mov_b32 v180, 0
    v_mov_b32 v181, 0
    v_mov_b32 v182, 0
    v_mov_b32 v183, 0
    v_mov_b32 v184, 0
    v_mov_b32 v185, 0
    v_mov_b32 v186, 0
    v_mov_b32 v187, 0
    v_mov_b32 v188, 0
    v_mov_b32 v189, 0
    v_mov_b32 v190, 0
    v_mov_b32 v191, 0
    s_mov_b32 s25, 0
L_fb2:
    s_add_u32 m0, s21, 0
    s_add_u32 s22, s25, 0
    buffer_load_dwordx4 v228, s[8:11], s22 offen nt lds
    buffer_load_dwordx4 v229, s[8:11], s22 offen offset:1056 nt lds
    buffer_load_dwordx4 v228, s[12:15], s22 offen offset:2112 nt lds
    buffer_load_dwordx4 v229, s[12:15], s22 offen offset:3168 nt lds
    s_add_u32 m0, s21, 4224
    s_add_u32 s22, s25, 2048
    buffer_load_dwordx4 v228, s[8:11], s22 offen nt lds
    buffer_load_dwordx4 v229, s[8:11], s22 offen offset:1056 nt lds
    buffer_load_dwordx4 v228, s[12:15], s22 offen offset:2112 nt lds
    buffer_load_dwordx4 v229, s[12:15], s22 offen offset:3168 nt lds
    s_add_u32 m0, s21, 8448
    s_add_u32 s22, s25, 4096
    buffer_load_dwordx4 v228, s[8:11], s22 offen nt lds
    buffer_load_dwordx4 v229, s[8:11], s22 offen offset:1056 nt lds
    buffer_load_dwordx4 v228, s[12:15], s22 offen offset:2112 nt lds
    buffer_load_dwordx4 v229, s[12:15], s22 offen offset:3168 nt lds
    s_add_u32 m0, s21, 12672
    s_add_u32 s22, s25, 6144
    buffer_load_dwordx4 v228, s[8:11], s22 offen nt lds
    buffer_load_dwordx4 v229, s[8:11], s22 offen offset:1056 nt lds
    buffer_load_dwordx4 v228, s[12:15], s22 offen offset:2112 nt lds
    buffer_load_dwordx4 v229, s[12:15], s22 offen offset:3168 nt lds
    s_waitcnt vmcnt(0)
    ds_read_b128 a[96:99], v230 offset:0
    ds_read_b128 a[100:103], v230 offset:256
    ds_read_b128 a[104:107], v230 offset:512
    ds_read_b128 a[108:111], v230 offset:768
    ds_read_b128 a[112:115], v230 offset:8448
    ds_read_b128 a[116:119], v230 offset:8704
    ds_read_b128 a[120:123], v230 offset:8960
    ds_read_b128 a[124:127], v230 offset:9216
    ds_read_b64_tr_b16 a[160:161], v231 offset:0
    ds_read_b64_tr_b16 a[162:163], v231 offset:8448
    ds_read_b64_tr_b16 a[164:165], v231 offset:32
    ds_read_b64_tr_b16 a[166:167], v231 offset:8480
    ds_read_b64_tr_b16 a[168:169], v231 offset:256
    ds_read_b64_tr_b16 a[170:171], v231 offset:8704
    ds_read_b64_tr_b16 a[172:173], v231 offset:288
    ds_read_b64_tr_b16 a[174:175], v231 offset:8736
    ds_read_b64_tr_b16 a[176:177], v231 offset:512
    ds_read_b64_tr_b16 a[178:179], v231 offset:8960
    ds_read_b64_tr_b16 a[180:181], v231 offset:544
    ds_read_b64_tr_b16 a[182:183], v231 offset:8992
    ds_read_b64_tr_b16 a[184:185], v231 offset:768
    ds_read_b64_tr_b16 a[186:187], v231 offset:9216
    ds_read_b64_tr_b16 a[188:189], v231 offset:800
    ds_read_b64_tr_b16 a[190:191], v231 offset:9248
    s_waitcnt lgkmcnt(0)
    v_mfma_f32_16x16x32_bf16 v[192:195], a[96:99], a[0:3], v[232:235]
    v_mfma_f32_16x16x32_bf16 v[192:195], a[100:103], a[4:7], v[192:195]
    v_mfma_f32_16x16x32_bf16 v[192:195], a[104:107], a[8:11], v[192:195]
    v_mfma_f32_16x16x32_bf16 v[192:195], a[108:111], a[12:15], v[192:195]
    v_mfma_f32_16x16x32_bf16 v[196:199], a[124:127], a[12:15], v[232:235]
    v_mfma_f32_16x16x32_bf16 v[196:199], a[120:123], a[8:11], v[196:199]
    v_mfma_f32_16x16x32_bf16 v[196:199], a[116:119], a[4:7], v[196:199]
    v_mfma_f32_16x16x32_bf16 v[196:199], a[112:115], a[0:3], v[196:199]
    s_nop 7
    s_nop 1
    v_exp_f32 v192, v192
    v_exp_f32 v193, v193
    v_exp_f32 v194, v194
    v_exp_f32 v195, v195
    v_exp_f32 v196, v196
    v_exp_f32 v197, v197
    v_exp_f32 v198, v198
    v_exp_f32 v199, v199
    s_nop 0
    v_add_f32 v216, v216, v192
    v_add_f32 v216, v216, v193
    v_add_f32 v216, v216, v194
    v_add_f32 v216, v216, v195
    v_add_f32 v216, v216, v196
    v_add_f32 v216, v216, v197
    v_add_f32 v216, v216, v198
    v_add_f32 v216, v216, v199
    v_cvt_pk_bf16_f32 v208, v192, v193
    v_cvt_pk_bf16_f32 v209, v194, v195
    v_cvt_pk_bf16_f32 v210, v196, v197
    v_cvt_pk_bf16_f32 v211, v198, v199
    s_nop 1
    v_mfma_f32_16x16x32_bf16 v[0:3], a[160:163], v[208:211], v[0:3]
    v_mfma_f32_16x16x32_bf16 v[4:7], a[164:167], v[208:211], v[4:7]
    v_mfma_f32_16x16x32_bf16 v[8:11], a[168:171], v[208:211], v[8:11]
    v_mfma_f32_16x16x32_bf16 v[12:15], a[172:175], v[208:211], v[12:15]
    v_mfma_f32_16x16x32_bf16 v[16:19], a[176:179], v[208:211], v[16:19]
    v_mfma_f32_16x16x32_bf16 v[20:23], a[180:183], v[208:211], v[20:23]
    v_mfma_f32_16x16x32_bf16 v[24:27], a[184:187], v[208:211], v[24:27]
    v_mfma_f32_16x16x32_bf16 v[28:31], a[188:191], v[208:211], v[28:31]
    v_mfma_f32_16x16x32_bf16 v[200:203], a[96:99], a[16:19], v[236:239]
    v_mfma_f32_16x16x32_bf16 v[200:203], a[100:103], a[20:23], v[200:203]
    v_mfma_f32_16x16x32_bf16 v[200:203], a[104:107], a[24:27], v[200:203]
    v_mfma_f32_16x16x32_bf16 v[200:203], a[108:111], a[28:31], v[200:203]
    v_mfma_f32_16x16x32_bf16 v[204:207], a[124:127], a[28:31], v[236:239]
    v_mfma_f32_16x16x32_bf16 v[204:207], a[120:123], a[24:27], v[204:207]
    v_mfma_f32_16x16x32_bf16 v[204:207], a[116:119], a[20:23], v[204:207]
    v_mfma_f32_16x16x32_bf16 v[204:207], a[112:115], a[16:19], v[204:207]
    s_nop 7
    s_nop 1
    v_exp_f32 v200, v200
    v_exp_f32 v201, v201
    v_exp_f32 v202, v202
    v_exp_f32 v203, v203
    v_exp_f32 v204, v204
    v_exp_f32 v205, v205
    v_exp_f32 v206, v206
    v_exp_f32 v207, v207
    s_nop 0
    v_add_f32 v217, v217, v200
    v_add_f32 v217, v217, v201
    v_add_f32 v217, v217, v202
    v_add_f32 v217, v217, v203
    v_add_f32 v217, v217, v204
    v_add_f32 v217, v217, v205
    v_add_f32 v217, v217, v206
    v_add_f32 v217, v217, v207
    v_cvt_pk_bf16_f32 v212, v200, v201
    v_cvt_pk_bf16_f32 v213, v202, v203
    v_cvt_pk_bf16_f32 v214, v204, v205
    v_cvt_pk_bf16_f32 v215, v206, v207
    s_nop 1
    v_mfma_f32_16x16x32_bf16 v[32:35], a[160:163], v[212:215], v[32:35]
    v_mfma_f32_16x16x32_bf16 v[36:39], a[164:167], v[212:215], v[36:39]
    v_mfma_f32_16x16x32_bf16 v[40:43], a[168:171], v[212:215], v[40:43]
    v_mfma_f32_16x16x32_bf16 v[44:47], a[172:175], v[212:215], v[44:47]
    v_mfma_f32_16x16x32_bf16 v[48:51], a[176:179], v[212:215], v[48:51]
    v_mfma_f32_16x16x32_bf16 v[52:55], a[180:183], v[212:215], v[52:55]
    v_mfma_f32_16x16x32_bf16 v[56:59], a[184:187], v[212:215], v[56:59]
    v_mfma_f32_16x16x32_bf16 v[60:63], a[188:191], v[212:215], v[60:63]
    v_mfma_f32_16x16x32_bf16 v[192:195], a[96:99], a[32:35], v[240:243]
    v_mfma_f32_16x16x32_bf16 v[192:195], a[100:103], a[36:39], v[192:195]
    v_mfma_f32_16x16x32_bf16 v[192:195], a[104:107], a[40:43], v[192:195]
    v_mfma_f32_16x16x32_bf16 v[192:195], a[108:111], a[44:47], v[192:195]
    v_mfma_f32_16x16x32_bf16 v[196:199], a[124:127], a[44:47], v[240:243]
    v_mfma_f32_16x16x32_bf16 v[196:199], a[120:123], a[40:43], v[196:199]
    v_mfma_f32_16x16x32_bf16 v[196:199], a[116:119], a[36:39], v[196:199]
    v_mfma_f32_16x16x32_bf16 v[196:199], a[112:115], a[32:35], v[196:199]
    s_nop 7
    s_nop 1
    v_exp_f32 v192, v192
    v_exp_f32 v193, v193
    v_exp_f32 v194, v194
    v_exp_f32 v195, v195
    v_exp_f32 v196, v196
    v_exp_f32 v197, v197
    v_exp_f32 v198, v198
    v_exp_f32 v199, v199
    s_nop 0
    v_add_f32 v218, v218, v192
    v_add_f32 v218, v218, v193
    v_add_f32 v218, v218, v194
    v_add_f32 v218, v218, v195
    v_add_f32 v218, v218, v196
    v_add_f32 v218, v218, v197
    v_add_f32 v218, v218, v198
    v_add_f32 v218, v218, v199
    v_cvt_pk_bf16_f32 v208, v192, v193
    v_cvt_pk_bf16_f32 v209, v194, v195
    v_cvt_pk_bf16_f32 v210, v196, v197
    v_cvt_pk_bf16_f32 v211, v198, v199
    s_nop 1
    v_mfma_f32_16x16x32_bf16 v[64:67], a[160:163], v[208:211], v[64:67]
    v_mfma_f32_16x16x32_bf16 v[68:71], a[164:167], v[208:211], v[68:71]
    v_mfma_f32_16x16x32_bf16 v[72:75], a[168:171], v[208:211], v[72:75]
    v_mfma_f32_16x16x32_bf16 v[76:79], a[172:175], v[208:211], v[76:79]
    v_mfma_f32_16x16x32_bf16 v[80:83], a[176:179], v[208:211], v[80:83]
    v_mfma_f32_16x16x32_bf16 v[84:87], a[180:183], v[208:211], v[84:87]
    v_mfma_f32_16x16x32_bf16 v[88:91], a[184:187], v[208:211], v[88:91]
    v_mfma_f32_16x16x32_bf16 v[92:95], a[188:191], v[208:211], v[92:95]
    v_mfma_f32_16x16x32_bf16 v[200:203], a[96:99], a[48:51], v[244:247]
    v_mfma_f32_16x16x32_bf16 v[200:203], a[100:103], a[52:55], v[200:203]
    v_mfma_f32_16x16x32_bf16 v[200:203], a[104:107], a[56:59], v[200:203]
    v_mfma_f32_16x16x32_bf16 v[200:203], a[108:111], a[60:63], v[200:203]
    v_mfma_f32_16x16x32_bf16 v[204:207], a[124:127], a[60:63], v[244:247]
    v_mfma_f32_16x16x32_bf16 v[204:207], a[120:123], a[56:59], v[204:207]
    v_mfma_f32_16x16x32_bf16 v[204:207], a[116:119], a[52:55], v[204:207]
    v_mfma_f32_16x16x32_bf16 v[204:207], a[112:115], a[48:51], v[204:207]
    s_nop 7
    s_nop 1
    v_exp_f32 v200, v200
    v_exp_f32 v201, v201
    v_exp_f32 v202, v202
    v_exp_f32 v203, v203
    v_exp_f32 v204, v204
    v_exp_f32 v205, v205
    v_exp_f32 v206, v206
    v_exp_f32 v207, v207
    s_nop 0
    v_add_f32 v219, v219, v200
    v_add_f32 v219, v219, v201
    v_add_f32 v219, v219, v202
    v_add_f32 v219, v219, v203
    v_add_f32 v219, v219, v204
    v_add_f32 v219, v219, v205
    v_add_f32 v219, v219, v206
    v_add_f32 v219, v219, v207
    v_cvt_pk_bf16_f32 v212, v200, v201
    v_cvt_pk_bf16_f32 v213, v202, v203
    v_cvt_pk_bf16_f32 v214, v204, v205
    v_cvt_pk_bf16_f32 v215, v206, v207
    s_nop 1
    v_mfma_f32_16x16x32_bf16 v[96:99], a[160:163], v[212:215], v[96:99]
    v_mfma_f32_16x16x32_bf16 v[100:103], a[164:167], v[212:215], v[100:103]
    v_mfma_f32_16x16x32_bf16 v[104:107], a[168:171], v[212:215], v[104:107]
    v_mfma_f32_16x16x32_bf16 v[108:111], a[172:175], v[212:215], v[108:111]
    v_mfma_f32_16x16x32_bf16 v[112:115], a[176:179], v[212:215], v[112:115]
    v_mfma_f32_16x16x32_bf16 v[116:119], a[180:183], v[212:215], v[116:119]
    v_mfma_f32_16x16x32_bf16 v[120:123], a[184:187], v[212:215], v[120:123]
    v_mfma_f32_16x16x32_bf16 v[124:127], a[188:191], v[212:215], v[124:127]
    v_mfma_f32_16x16x32_bf16 v[192:195], a[96:99], a[64:67], v[248:251]
    v_mfma_f32_16x16x32_bf16 v[192:195], a[100:103], a[68:71], v[192:195]
    v_mfma_f32_16x16x32_bf16 v[192:195], a[104:107], a[72:75], v[192:195]
    v_mfma_f32_16x16x32_bf16 v[192:195], a[108:111], a[76:79], v[192:195]
    v_mfma_f32_16x16x32_bf16 v[196:199], a[124:127], a[76:79], v[248:251]
    v_mfma_f32_16x16x32_bf16 v[196:199], a[120:123], a[72:75], v[196:199]
    v_mfma_f32_16x16x32_bf16 v[196:199], a[116:119], a[68:71], v[196:199]
    v_mfma_f32_16x16x32_bf16 v[196:199], a[112:115], a[64:67], v[196:199]
    s_nop 7
    s_nop 1
    v_exp_f32 v192, v192
    v_exp_f32 v193, v193
    v_exp_f32 v194, v194
    v_exp_f32 v195, v195
    v_exp_f32 v196, v196
    v_exp_f32 v197, v197
    v_exp_f32 v198, v198
    v_exp_f32 v199, v199
    s_nop 0
    v_add_f32 v220, v220, v192
    v_add_f32 v220, v220, v193
    v_add_f32 v220, v220, v194
    v_add_f32 v220, v220, v195
    v_add_f32 v220, v220, v196
    v_add_f32 v220, v220, v197
    v_add_f32 v220, v220, v198
    v_add_f32 v220, v220, v199
    v_cvt_pk_bf16_f32 v208, v192, v193
    v_cvt_pk_bf16_f32 v209, v194, v195
    v_cvt_pk_bf16_f32 v210, v196, v197
    v_cvt_pk_bf16_f32 v211, v198, v199
    s_nop 1
    v_mfma_f32_16x16x32_bf16 v[128:131], a[160:163], v[208:211], v[128:131]
    v_mfma_f32_16x16x32_bf16 v[132:135], a[164:167], v[208:211], v[132:135]
    v_mfma_f32_16x16x32_bf16 v[136:139], a[168:171], v[208:211], v[136:139]
    v_mfma_f32_16x16x32_bf16 v[140:143], a[172:175], v[208:211], v[140:143]
    v_mfma_f32_16x16x32_bf16 v[144:147], a[176:179], v[208:211], v[144:147]
    v_mfma_f32_16x16x32_bf16 v[148:151], a[180:183], v[208:211], v[148:151]
    v_mfma_f32_16x16x32_bf16 v[152:155], a[184:187], v[208:211], v[152:155]
    v_mfma_f32_16x16x32_bf16 v[156:159], a[188:191], v[208:211], v[156:159]
    v_mfma_f32_16x16x32_bf16 v[200:203], a[96:99], a[80:83], v[252:255]
    v_mfma_f32_16x16x32_bf16 v[200:203], a[100:103], a[84:87], v[200:203]
    v_mfma_f32_16x16x32_bf16 v[200:203], a[104:107], a[88:91], v[200:203]
    v_mfma_f32_16x16x32_bf16 v[200:203], a[108:111], a[92:95], v[200:203]
    v_mfma_f32_16x16x32_bf16 v[204:207], a[124:127], a[92:95], v[252:255]
    v_mfma_f32_16x16x32_bf16 v[204:207], a[120:123], a[88:91], v[204:207]
    v_mfma_f32_16x16x32_bf16 v[204:207], a[116:119], a[84:87], v[204:207]
    v_mfma_f32_16x16x32_bf16 v[204:207], a[112:115], a[80:83], v[204:207]
    s_nop 7
    s_nop 1
    v_exp_f32 v200, v200
    v_exp_f32 v201, v201
    v_exp_f32 v202, v202
    v_exp_f32 v203, v203
    v_exp_f32 v204, v204
    v_exp_f32 v205, v205
    v_exp_f32 v206, v206
    v_exp_f32 v207, v207
    s_nop 0
    v_add_f32 v221, v221, v200
    v_add_f32 v221, v221, v201
    v_add_f32 v221, v221, v202
    v_add_f32 v221, v221, v203
    v_add_f32 v221, v221, v204
    v_add_f32 v221, v221, v205
    v_add_f32 v221, v221, v206
    v_add_f32 v221, v221, v207
    v_cvt_pk_bf16_f32 v212, v200, v201
    v_cvt_pk_bf16_f32 v213, v202, v203
    v_cvt_pk_bf16_f32 v214, v204, v205
    v_cvt_pk_bf16_f32 v215, v206, v207
    s_nop 1
    v_mfma_f32_16x16x32_bf16 v[160:163], a[160:163], v[212:215], v[160:163]
    v_mfma_f32_16x16x32_bf16 v[164:167], a[164:167], v[212:215], v[164:167]
    v_mfma_f32_16x16x32_bf16 v[168:171], a[168:171], v[212:215], v[168:171]
    v_mfma_f32_16x16x32_bf16 v[172:175], a[172:175], v[212:215], v[172:175]
    v_mfma_f32_16x16x32_bf16 v[176:179], a[176:179], v[212:215], v[176:179]
    v_mfma_f32_16x16x32_bf16 v[180:183], a[180:183], v[212:215], v[180:183]
    v_mfma_f32_16x16x32_bf16 v[184:187], a[184:187], v[212:215], v[184:187]
    v_mfma_f32_16x16x32_bf16 v[188:191], a[188:191], v[212:215], v[188:191]
    s_add_u32 s25, s25, 8192
    s_cmp_lt_u32 s25, 524288
    s_cbranch_scc1 L_fb2
    v_mov_b32 v232, v216
    s_nop 1
    v_mov_b32 v233, v217
    s_nop 1
    v_mov_b32 v234, v218
    s_nop 1
    v_mov_b32 v235, v219
    s_nop 1
    v_mov_b32 v236, v220
    s_nop 1
    v_mov_b32 v237, v221
    s_nop 1
    v_permlane32_swap_b32 v216, v232
    s_nop 1
    v_permlane32_swap_b32 v217, v233
    s_nop 1
    v_permlane32_swap_b32 v218, v234
    s_nop 1
    v_permlane32_swap_b32 v219, v235
    s_nop 1
    v_permlane32_swap_b32 v220, v236
    s_nop 1
    v_permlane32_swap_b32 v221, v237
    s_nop 1
    v_add_f32 v216, v216, v232
    s_nop 1
    v_add_f32 v217, v217, v233
    s_nop 1
    v_add_f32 v218, v218, v234
    s_nop 1
    v_add_f32 v219, v219, v235
    s_nop 1
    v_add_f32 v220, v220, v236
    s_nop 1
    v_add_f32 v221, v221, v237
    s_nop 1
    v_mov_b32 v232, v216
    s_nop 1
    v_mov_b32 v233, v217
    s_nop 1
    v_mov_b32 v234, v218
    s_nop 1
    v_mov_b32 v235, v219
    s_nop 1
    v_mov_b32 v236, v220
    s_nop 1
    v_mov_b32 v237, v221
    s_nop 1
    v_permlane16_swap_b32 v216, v232
    s_nop 1
    v_permlane16_swap_b32 v217, v233
    s_nop 1
    v_permlane16_swap_b32 v218, v234
    s_nop 1
    v_permlane16_swap_b32 v219, v235
    s_nop 1
    v_permlane16_swap_b32 v220, v236
    s_nop 1
    v_permlane16_swap_b32 v221, v237
    s_nop 1
    v_add_f32 v216, v216, v232
    s_nop 1
    v_add_f32 v217, v217, v233
    s_nop 1
    v_add_f32 v218, v218, v234
    s_nop 1
    v_add_f32 v219, v219, v235
    s_nop 1
    v_add_f32 v220, v220, v236
    s_nop 1
    v_add_f32 v221, v221, v237
    s_nop 1
    s_nop 7
    v_rcp_f32 v216, v216
    v_rcp_f32 v217, v217
    v_rcp_f32 v218, v218
    v_rcp_f32 v219, v219
    v_rcp_f32 v220, v220
    v_rcp_f32 v221, v221
    s_mul_i32 s25, s20, 8704
    s_add_u32 s25, s25, 101376
    v_and_b32 v228, 15, v226
    v_lshrrev_b32 v229, 4, v226
    v_mul_u32_u24 v230, 272, v228
    v_lshl_add_u32 v230, v229, 3, v230
    v_add_u32 v230, s25, v230
    v_mul_u32_u24 v231, 272, v229
    v_lshl_add_u32 v231, v228, 4, v231
    v_add_u32 v231, s25, v231
    s_mul_i32 s25, s20, 24576
    v_lshlrev_b32 v227, 4, v226
    v_add_u32 v227, s25, v227
    v_mov_b32 v228, v216
    v_mov_b32 v229, v216
    v_pk_mul_f32 v[0:1], v[0:1], v[228:229]
    v_pk_mul_f32 v[2:3], v[2:3], v[228:229]
    v_pk_mul_f32 v[4:5], v[4:5], v[228:229]
    v_pk_mul_f32 v[6:7], v[6:7], v[228:229]
    v_pk_mul_f32 v[8:9], v[8:9], v[228:229]
    v_pk_mul_f32 v[10:11], v[10:11], v[228:229]
    v_pk_mul_f32 v[12:13], v[12:13], v[228:229]
    v_pk_mul_f32 v[14:15], v[14:15], v[228:229]
    v_pk_mul_f32 v[16:17], v[16:17], v[228:229]
    v_pk_mul_f32 v[18:19], v[18:19], v[228:229]
    v_pk_mul_f32 v[20:21], v[20:21], v[228:229]
    v_pk_mul_f32 v[22:23], v[22:23], v[228:229]
    v_pk_mul_f32 v[24:25], v[24:25], v[228:229]
    v_pk_mul_f32 v[26:27], v[26:27], v[228:229]
    v_pk_mul_f32 v[28:29], v[28:29], v[228:229]
    v_pk_mul_f32 v[30:31], v[30:31], v[228:229]
    v_cvt_pk_bf16_f32 v0, v0, v1
    v_cvt_pk_bf16_f32 v1, v2, v3
    ds_write_b64 v230, v[0:1] offset:0
    v_cvt_pk_bf16_f32 v4, v4, v5
    v_cvt_pk_bf16_f32 v5, v6, v7
    ds_write_b64 v230, v[4:5] offset:32
    v_cvt_pk_bf16_f32 v8, v8, v9
    v_cvt_pk_bf16_f32 v9, v10, v11
    ds_write_b64 v230, v[8:9] offset:64
    v_cvt_pk_bf16_f32 v12, v12, v13
    v_cvt_pk_bf16_f32 v13, v14, v15
    ds_write_b64 v230, v[12:13] offset:96
    v_cvt_pk_bf16_f32 v16, v16, v17
    v_cvt_pk_bf16_f32 v17, v18, v19
    ds_write_b64 v230, v[16:17] offset:128
    v_cvt_pk_bf16_f32 v20, v20, v21
    v_cvt_pk_bf16_f32 v21, v22, v23
    ds_write_b64 v230, v[20:21] offset:160
    v_cvt_pk_bf16_f32 v24, v24, v25
    v_cvt_pk_bf16_f32 v25, v26, v27
    ds_write_b64 v230, v[24:25] offset:192
    v_cvt_pk_bf16_f32 v28, v28, v29
    v_cvt_pk_bf16_f32 v29, v30, v31
    ds_write_b64 v230, v[28:29] offset:224
    ds_read_b128 v[0:3], v231 offset:0
    ds_read_b128 v[4:7], v231 offset:1088
    ds_read_b128 v[8:11], v231 offset:2176
    ds_read_b128 v[12:15], v231 offset:3264
    v_mov_b32 v228, v217
    v_mov_b32 v229, v217
    v_pk_mul_f32 v[32:33], v[32:33], v[228:229]
    v_pk_mul_f32 v[34:35], v[34:35], v[228:229]
    v_pk_mul_f32 v[36:37], v[36:37], v[228:229]
    v_pk_mul_f32 v[38:39], v[38:39], v[228:229]
    v_pk_mul_f32 v[40:41], v[40:41], v[228:229]
    v_pk_mul_f32 v[42:43], v[42:43], v[228:229]
    v_pk_mul_f32 v[44:45], v[44:45], v[228:229]
    v_pk_mul_f32 v[46:47], v[46:47], v[228:229]
    v_pk_mul_f32 v[48:49], v[48:49], v[228:229]
    v_pk_mul_f32 v[50:51], v[50:51], v[228:229]
    v_pk_mul_f32 v[52:53], v[52:53], v[228:229]
    v_pk_mul_f32 v[54:55], v[54:55], v[228:229]
    v_pk_mul_f32 v[56:57], v[56:57], v[228:229]
    v_pk_mul_f32 v[58:59], v[58:59], v[228:229]
    v_pk_mul_f32 v[60:61], v[60:61], v[228:229]
    v_pk_mul_f32 v[62:63], v[62:63], v[228:229]
    v_cvt_pk_bf16_f32 v32, v32, v33
    v_cvt_pk_bf16_f32 v33, v34, v35
    ds_write_b64 v230, v[32:33] offset:4352
    v_cvt_pk_bf16_f32 v36, v36, v37
    v_cvt_pk_bf16_f32 v37, v38, v39
    ds_write_b64 v230, v[36:37] offset:4384
    v_cvt_pk_bf16_f32 v40, v40, v41
    v_cvt_pk_bf16_f32 v41, v42, v43
    ds_write_b64 v230, v[40:41] offset:4416
    v_cvt_pk_bf16_f32 v44, v44, v45
    v_cvt_pk_bf16_f32 v45, v46, v47
    ds_write_b64 v230, v[44:45] offset:4448
    v_cvt_pk_bf16_f32 v48, v48, v49
    v_cvt_pk_bf16_f32 v49, v50, v51
    ds_write_b64 v230, v[48:49] offset:4480
    v_cvt_pk_bf16_f32 v52, v52, v53
    v_cvt_pk_bf16_f32 v53, v54, v55
    ds_write_b64 v230, v[52:53] offset:4512
    v_cvt_pk_bf16_f32 v56, v56, v57
    v_cvt_pk_bf16_f32 v57, v58, v59
    ds_write_b64 v230, v[56:57] offset:4544
    v_cvt_pk_bf16_f32 v60, v60, v61
    v_cvt_pk_bf16_f32 v61, v62, v63
    ds_write_b64 v230, v[60:61] offset:4576
    s_waitcnt lgkmcnt(8)
    s_mov_b32 s24, 0
    buffer_store_dwordx4 v[0:3], v227, s[16:19], s24 offen offset:0 sc0 sc1 nt
    buffer_store_dwordx4 v[4:7], v227, s[16:19], s24 offen offset:1024 sc0 sc1 nt
    buffer_store_dwordx4 v[8:11], v227, s[16:19], s24 offen offset:2048 sc0 sc1 nt
    buffer_store_dwordx4 v[12:15], v227, s[16:19], s24 offen offset:3072 sc0 sc1 nt
    ds_read_b128 v[32:35], v231 offset:4352
    ds_read_b128 v[36:39], v231 offset:5440
    ds_read_b128 v[40:43], v231 offset:6528
    ds_read_b128 v[44:47], v231 offset:7616
    v_mov_b32 v228, v218
    v_mov_b32 v229, v218
    v_pk_mul_f32 v[64:65], v[64:65], v[228:229]
    v_pk_mul_f32 v[66:67], v[66:67], v[228:229]
    v_pk_mul_f32 v[68:69], v[68:69], v[228:229]
    v_pk_mul_f32 v[70:71], v[70:71], v[228:229]
    v_pk_mul_f32 v[72:73], v[72:73], v[228:229]
    v_pk_mul_f32 v[74:75], v[74:75], v[228:229]
    v_pk_mul_f32 v[76:77], v[76:77], v[228:229]
    v_pk_mul_f32 v[78:79], v[78:79], v[228:229]
    v_pk_mul_f32 v[80:81], v[80:81], v[228:229]
    v_pk_mul_f32 v[82:83], v[82:83], v[228:229]
    v_pk_mul_f32 v[84:85], v[84:85], v[228:229]
    v_pk_mul_f32 v[86:87], v[86:87], v[228:229]
    v_pk_mul_f32 v[88:89], v[88:89], v[228:229]
    v_pk_mul_f32 v[90:91], v[90:91], v[228:229]
    v_pk_mul_f32 v[92:93], v[92:93], v[228:229]
    v_pk_mul_f32 v[94:95], v[94:95], v[228:229]
    v_cvt_pk_bf16_f32 v64, v64, v65
    v_cvt_pk_bf16_f32 v65, v66, v67
    ds_write_b64 v230, v[64:65] offset:0
    v_cvt_pk_bf16_f32 v68, v68, v69
    v_cvt_pk_bf16_f32 v69, v70, v71
    ds_write_b64 v230, v[68:69] offset:32
    v_cvt_pk_bf16_f32 v72, v72, v73
    v_cvt_pk_bf16_f32 v73, v74, v75
    ds_write_b64 v230, v[72:73] offset:64
    v_cvt_pk_bf16_f32 v76, v76, v77
    v_cvt_pk_bf16_f32 v77, v78, v79
    ds_write_b64 v230, v[76:77] offset:96
    v_cvt_pk_bf16_f32 v80, v80, v81
    v_cvt_pk_bf16_f32 v81, v82, v83
    ds_write_b64 v230, v[80:81] offset:128
    v_cvt_pk_bf16_f32 v84, v84, v85
    v_cvt_pk_bf16_f32 v85, v86, v87
    ds_write_b64 v230, v[84:85] offset:160
    v_cvt_pk_bf16_f32 v88, v88, v89
    v_cvt_pk_bf16_f32 v89, v90, v91
    ds_write_b64 v230, v[88:89] offset:192
    v_cvt_pk_bf16_f32 v92, v92, v93
    v_cvt_pk_bf16_f32 v93, v94, v95
    ds_write_b64 v230, v[92:93] offset:224
    s_waitcnt lgkmcnt(8)
    s_mov_b32 s24, 4096
    buffer_store_dwordx4 v[32:35], v227, s[16:19], s24 offen offset:0 sc0 sc1 nt
    buffer_store_dwordx4 v[36:39], v227, s[16:19], s24 offen offset:1024 sc0 sc1 nt
    buffer_store_dwordx4 v[40:43], v227, s[16:19], s24 offen offset:2048 sc0 sc1 nt
    buffer_store_dwordx4 v[44:47], v227, s[16:19], s24 offen offset:3072 sc0 sc1 nt
    ds_read_b128 v[64:67], v231 offset:0
    ds_read_b128 v[68:71], v231 offset:1088
    ds_read_b128 v[72:75], v231 offset:2176
    ds_read_b128 v[76:79], v231 offset:3264
    v_mov_b32 v228, v219
    v_mov_b32 v229, v219
    v_pk_mul_f32 v[96:97], v[96:97], v[228:229]
    v_pk_mul_f32 v[98:99], v[98:99], v[228:229]
    v_pk_mul_f32 v[100:101], v[100:101], v[228:229]
    v_pk_mul_f32 v[102:103], v[102:103], v[228:229]
    v_pk_mul_f32 v[104:105], v[104:105], v[228:229]
    v_pk_mul_f32 v[106:107], v[106:107], v[228:229]
    v_pk_mul_f32 v[108:109], v[108:109], v[228:229]
    v_pk_mul_f32 v[110:111], v[110:111], v[228:229]
    v_pk_mul_f32 v[112:113], v[112:113], v[228:229]
    v_pk_mul_f32 v[114:115], v[114:115], v[228:229]
    v_pk_mul_f32 v[116:117], v[116:117], v[228:229]
    v_pk_mul_f32 v[118:119], v[118:119], v[228:229]
    v_pk_mul_f32 v[120:121], v[120:121], v[228:229]
    v_pk_mul_f32 v[122:123], v[122:123], v[228:229]
    v_pk_mul_f32 v[124:125], v[124:125], v[228:229]
    v_pk_mul_f32 v[126:127], v[126:127], v[228:229]
    v_cvt_pk_bf16_f32 v96, v96, v97
    v_cvt_pk_bf16_f32 v97, v98, v99
    ds_write_b64 v230, v[96:97] offset:4352
    v_cvt_pk_bf16_f32 v100, v100, v101
    v_cvt_pk_bf16_f32 v101, v102, v103
    ds_write_b64 v230, v[100:101] offset:4384
    v_cvt_pk_bf16_f32 v104, v104, v105
    v_cvt_pk_bf16_f32 v105, v106, v107
    ds_write_b64 v230, v[104:105] offset:4416
    v_cvt_pk_bf16_f32 v108, v108, v109
    v_cvt_pk_bf16_f32 v109, v110, v111
    ds_write_b64 v230, v[108:109] offset:4448
    v_cvt_pk_bf16_f32 v112, v112, v113
    v_cvt_pk_bf16_f32 v113, v114, v115
    ds_write_b64 v230, v[112:113] offset:4480
    v_cvt_pk_bf16_f32 v116, v116, v117
    v_cvt_pk_bf16_f32 v117, v118, v119
    ds_write_b64 v230, v[116:117] offset:4512
    v_cvt_pk_bf16_f32 v120, v120, v121
    v_cvt_pk_bf16_f32 v121, v122, v123
    ds_write_b64 v230, v[120:121] offset:4544
    v_cvt_pk_bf16_f32 v124, v124, v125
    v_cvt_pk_bf16_f32 v125, v126, v127
    ds_write_b64 v230, v[124:125] offset:4576
    s_waitcnt lgkmcnt(8)
    s_mov_b32 s24, 8192
    buffer_store_dwordx4 v[64:67], v227, s[16:19], s24 offen offset:0 sc0 sc1 nt
    buffer_store_dwordx4 v[68:71], v227, s[16:19], s24 offen offset:1024 sc0 sc1 nt
    buffer_store_dwordx4 v[72:75], v227, s[16:19], s24 offen offset:2048 sc0 sc1 nt
    buffer_store_dwordx4 v[76:79], v227, s[16:19], s24 offen offset:3072 sc0 sc1 nt
    ds_read_b128 v[96:99], v231 offset:4352
    ds_read_b128 v[100:103], v231 offset:5440
    ds_read_b128 v[104:107], v231 offset:6528
    ds_read_b128 v[108:111], v231 offset:7616
    v_mov_b32 v228, v220
    v_mov_b32 v229, v220
    v_pk_mul_f32 v[128:129], v[128:129], v[228:229]
    v_pk_mul_f32 v[130:131], v[130:131], v[228:229]
    v_pk_mul_f32 v[132:133], v[132:133], v[228:229]
    v_pk_mul_f32 v[134:135], v[134:135], v[228:229]
    v_pk_mul_f32 v[136:137], v[136:137], v[228:229]
    v_pk_mul_f32 v[138:139], v[138:139], v[228:229]
    v_pk_mul_f32 v[140:141], v[140:141], v[228:229]
    v_pk_mul_f32 v[142:143], v[142:143], v[228:229]
    v_pk_mul_f32 v[144:145], v[144:145], v[228:229]
    v_pk_mul_f32 v[146:147], v[146:147], v[228:229]
    v_pk_mul_f32 v[148:149], v[148:149], v[228:229]
    v_pk_mul_f32 v[150:151], v[150:151], v[228:229]
    v_pk_mul_f32 v[152:153], v[152:153], v[228:229]
    v_pk_mul_f32 v[154:155], v[154:155], v[228:229]
    v_pk_mul_f32 v[156:157], v[156:157], v[228:229]
    v_pk_mul_f32 v[158:159], v[158:159], v[228:229]
    v_cvt_pk_bf16_f32 v128, v128, v129
    v_cvt_pk_bf16_f32 v129, v130, v131
    ds_write_b64 v230, v[128:129] offset:0
    v_cvt_pk_bf16_f32 v132, v132, v133
    v_cvt_pk_bf16_f32 v133, v134, v135
    ds_write_b64 v230, v[132:133] offset:32
    v_cvt_pk_bf16_f32 v136, v136, v137
    v_cvt_pk_bf16_f32 v137, v138, v139
    ds_write_b64 v230, v[136:137] offset:64
    v_cvt_pk_bf16_f32 v140, v140, v141
    v_cvt_pk_bf16_f32 v141, v142, v143
    ds_write_b64 v230, v[140:141] offset:96
    v_cvt_pk_bf16_f32 v144, v144, v145
    v_cvt_pk_bf16_f32 v145, v146, v147
    ds_write_b64 v230, v[144:145] offset:128
    v_cvt_pk_bf16_f32 v148, v148, v149
    v_cvt_pk_bf16_f32 v149, v150, v151
    ds_write_b64 v230, v[148:149] offset:160
    v_cvt_pk_bf16_f32 v152, v152, v153
    v_cvt_pk_bf16_f32 v153, v154, v155
    ds_write_b64 v230, v[152:153] offset:192
    v_cvt_pk_bf16_f32 v156, v156, v157
    v_cvt_pk_bf16_f32 v157, v158, v159
    ds_write_b64 v230, v[156:157] offset:224
    s_waitcnt lgkmcnt(8)
    s_mov_b32 s24, 12288
    buffer_store_dwordx4 v[96:99], v227, s[16:19], s24 offen offset:0 sc0 sc1 nt
    buffer_store_dwordx4 v[100:103], v227, s[16:19], s24 offen offset:1024 sc0 sc1 nt
    buffer_store_dwordx4 v[104:107], v227, s[16:19], s24 offen offset:2048 sc0 sc1 nt
    buffer_store_dwordx4 v[108:111], v227, s[16:19], s24 offen offset:3072 sc0 sc1 nt
    ds_read_b128 v[128:131], v231 offset:0
    ds_read_b128 v[132:135], v231 offset:1088
    ds_read_b128 v[136:139], v231 offset:2176
    ds_read_b128 v[140:143], v231 offset:3264
    v_mov_b32 v228, v221
    v_mov_b32 v229, v221
    v_pk_mul_f32 v[160:161], v[160:161], v[228:229]
    v_pk_mul_f32 v[162:163], v[162:163], v[228:229]
    v_pk_mul_f32 v[164:165], v[164:165], v[228:229]
    v_pk_mul_f32 v[166:167], v[166:167], v[228:229]
    v_pk_mul_f32 v[168:169], v[168:169], v[228:229]
    v_pk_mul_f32 v[170:171], v[170:171], v[228:229]
    v_pk_mul_f32 v[172:173], v[172:173], v[228:229]
    v_pk_mul_f32 v[174:175], v[174:175], v[228:229]
    v_pk_mul_f32 v[176:177], v[176:177], v[228:229]
    v_pk_mul_f32 v[178:179], v[178:179], v[228:229]
    v_pk_mul_f32 v[180:181], v[180:181], v[228:229]
    v_pk_mul_f32 v[182:183], v[182:183], v[228:229]
    v_pk_mul_f32 v[184:185], v[184:185], v[228:229]
    v_pk_mul_f32 v[186:187], v[186:187], v[228:229]
    v_pk_mul_f32 v[188:189], v[188:189], v[228:229]
    v_pk_mul_f32 v[190:191], v[190:191], v[228:229]
    v_cvt_pk_bf16_f32 v160, v160, v161
    v_cvt_pk_bf16_f32 v161, v162, v163
    ds_write_b64 v230, v[160:161] offset:4352
    v_cvt_pk_bf16_f32 v164, v164, v165
    v_cvt_pk_bf16_f32 v165, v166, v167
    ds_write_b64 v230, v[164:165] offset:4384
    v_cvt_pk_bf16_f32 v168, v168, v169
    v_cvt_pk_bf16_f32 v169, v170, v171
    ds_write_b64 v230, v[168:169] offset:4416
    v_cvt_pk_bf16_f32 v172, v172, v173
    v_cvt_pk_bf16_f32 v173, v174, v175
    ds_write_b64 v230, v[172:173] offset:4448
    v_cvt_pk_bf16_f32 v176, v176, v177
    v_cvt_pk_bf16_f32 v177, v178, v179
    ds_write_b64 v230, v[176:177] offset:4480
    v_cvt_pk_bf16_f32 v180, v180, v181
    v_cvt_pk_bf16_f32 v181, v182, v183
    ds_write_b64 v230, v[180:181] offset:4512
    v_cvt_pk_bf16_f32 v184, v184, v185
    v_cvt_pk_bf16_f32 v185, v186, v187
    ds_write_b64 v230, v[184:185] offset:4544
    v_cvt_pk_bf16_f32 v188, v188, v189
    v_cvt_pk_bf16_f32 v189, v190, v191
    ds_write_b64 v230, v[188:189] offset:4576
    s_waitcnt lgkmcnt(8)
    s_mov_b32 s24, 16384
    buffer_store_dwordx4 v[128:131], v227, s[16:19], s24 offen offset:0 sc0 sc1 nt
    buffer_store_dwordx4 v[132:135], v227, s[16:19], s24 offen offset:1024 sc0 sc1 nt
    buffer_store_dwordx4 v[136:139], v227, s[16:19], s24 offen offset:2048 sc0 sc1 nt
    buffer_store_dwordx4 v[140:143], v227, s[16:19], s24 offen offset:3072 sc0 sc1 nt
    ds_read_b128 v[160:163], v231 offset:4352
    ds_read_b128 v[164:167], v231 offset:5440
    ds_read_b128 v[168:171], v231 offset:6528
    ds_read_b128 v[172:175], v231 offset:7616
    s_waitcnt lgkmcnt(0)
    s_mov_b32 s24, 20480
    buffer_store_dwordx4 v[160:163], v227, s[16:19], s24 offen offset:0 sc0 sc1 nt
    buffer_store_dwordx4 v[164:167], v227, s[16:19], s24 offen offset:1024 sc0 sc1 nt
    buffer_store_dwordx4 v[168:171], v227, s[16:19], s24 offen offset:2048 sc0 sc1 nt
    buffer_store_dwordx4 v[172:175], v227, s[16:19], s24 offen offset:3072 sc0 sc1 nt
    s_endpgm
.section .rodata,"a"
.p2align 6
.amdhsa_kernel standalone__mha_softmax__near_ridge_kernel
  .amdhsa_next_free_vgpr 512
  .amdhsa_next_free_sgpr 102
  .amdhsa_accum_offset 256
  .amdhsa_group_segment_fixed_size 0
  .amdhsa_kernarg_size 48
  .amdhsa_user_sgpr_count 2
  .amdhsa_user_sgpr_kernarg_segment_ptr 1
  .amdhsa_system_sgpr_workgroup_id_x 1
.end_amdhsa_kernel
```
